```python
import torch

def _softmax(x, axis=-1):
    return torch.softmax(x, dim=axis)
def _gelu(x):
    return torch.nn.functional.gelu(x, approximate="tanh")
def _silu(x):
    return torch.nn.functional.silu(x)
def _sigmoid(x):
    return torch.sigmoid(x)
def _layernorm(x, axis=-1, eps=1e-5):
    m = x.mean(dim=axis, keepdim=True)
    v = x.var(dim=axis, keepdim=True, unbiased=False)
    return (x - m) / torch.sqrt(v + eps)
def _scatter_add(tgt, idx, src, axis=0):
    return tgt.clone().index_add_(axis, idx, src)
def _segment_sum(src, seg, n):
    out = torch.zeros((n,) + src.shape[1:], dtype=src.dtype)
    return out.index_add_(0, seg, src)
def _pad(x, pw):
    flat = tuple(v for pair in reversed(pw) for v in pair)
    return torch.nn.functional.pad(x, flat)

kernel_name = 'parallel_sum__sliding_local_dilated__glu_gated_bilinear__prompt'

def setup_inputs():

    _w = (lambda a: (lambda t: t.to(torch.bfloat16) if t.is_floating_point() else t)(torch.as_tensor(a)))
    def _A_setup():
        B, S, D = 1, 2048, 640
        return {
            "x": _w((lambda *s: torch.randn(*s, dtype=torch.bfloat16) * 0.05)(B, S, D)),
            "wqkv": _w((lambda *s: torch.randn(*s, dtype=torch.bfloat16) * 0.05)(D, 3 * D)),
            "wo": _w((lambda *s: torch.randn(*s, dtype=torch.bfloat16) * 0.05)(D, D)),
        }
    _A_in = _A_setup()

    def _B_setup():
        B, S, D, F = 1, 2048, 640, 1536
        return {
            "x": _w((lambda *s: torch.randn(*s, dtype=torch.bfloat16) * 0.05)(B, S, D)),
            "w_gate": _w((lambda *s: torch.randn(*s, dtype=torch.bfloat16) * 0.8)(D, F) * (D ** -0.5)),
            "w_up": _w((lambda *s: torch.randn(*s, dtype=torch.bfloat16) * 0.8)(D, F) * (D ** -0.5)),
            "w_down": _w((lambda *s: torch.randn(*s, dtype=torch.bfloat16) * 0.8)(F, D) * (F ** -0.5)),
        }
    _B_in = _B_setup()

    return {
        "A_x": _A_in["x"],
        "A_wqkv": _A_in["wqkv"],
        "A_wo": _A_in["wo"],
        "B_x": _B_in["x"],
        "B_w_gate": _B_in["w_gate"],
        "B_w_up": _B_in["w_up"],
        "B_w_down": _B_in["w_down"],
    }

def reference(A_x, A_wqkv, A_wo, B_x, B_w_gate, B_w_up, B_w_down):
    def _A_ref(x, wqkv, wo):
        B, S, D = x.shape
        H = 32; Dh = D // H
        W, dil = 8, 2
        qkv = (lambda x, *d: x.permute(*d))((x @ wqkv).reshape(B, S, 3, H, Dh), 2, 0, 3, 1, 4)
        q, k, v = qkv[0], qkv[1], qkv[2]
        scale = Dh ** -0.5
        pos = torch.arange(S)
        off = torch.arange(W) * dil
        idx = pos[:, None] - off[None, :]
        mask = idx >= 0
        idx_c = torch.where(mask, idx, 0).reshape(-1)
        kg = k[:, :, idx_c, :].reshape(B, H, S, W, Dh)
        vg = v[:, :, idx_c, :].reshape(B, H, S, W, Dh)
        logits = torch.einsum("bhsd,bhswd->bhsw", q, kg) * scale
        logits = torch.where(mask[None, None, :, :], logits, -1e9)
        attn = _softmax(logits, axis=-1)
        o = torch.einsum("bhsw,bhswd->bhsd", attn, vg)
        return (lambda x, *d: x.permute(*d))(o, 0, 2, 1, 3).reshape(B, S, D) @ wo

    def _B_ref(x, w_gate, w_up, w_down):
        g = torch.einsum("bsd,df->bsf", x, w_gate)
        u = torch.einsum("bsd,df->bsf", x, w_up)
        h = g * u
        return torch.einsum("bsf,fd->bsd", h, w_down)

    x = A_x
    xn = _layernorm(x, axis=-1)
    return x + _A_ref(xn, A_wqkv, A_wo) + _B_ref(xn, B_w_gate, B_w_up, B_w_down)
```

```asm
; @launch grid=(256,1,1) block=(512,1,1) lds=163840
.amdgcn_target "amdgcn-amd-amdhsa--gfx950"
.text
.globl parallel_sum__sliding_local_dilated__glu_gated_bilinear__prompt_kernel
.p2align 8
.type parallel_sum__sliding_local_dilated__glu_gated_bilinear__prompt_kernel,@function
parallel_sum__sliding_local_dilated__glu_gated_bilinear__prompt_kernel:
    s_cmp_ge_u32 s2, 256
    s_cbranch_scc1 .Lexit
    s_load_dwordx16 s[4:19], s[0:1], 0
    s_load_dwordx4 s[20:23], s[0:1], 64
    s_getpc_b64 s[76:77]
    s_and_b32 s56, s2, 0xf8
    s_lshl_b32 s56, s56, 8
    v_lshl_add_u32 v247, v0, 2, s56
    v_min_u32 v247, 38688, v247
    s_mov_b32 exec_lo, 1
    s_mov_b32 exec_hi, 1
    global_load_dword v243, v247, s[76:77]
    s_mov_b64 exec, -1
    v_lshrrev_b32 v1, 6, v0
    v_and_b32 v254, 63, v0
    v_readfirstlane_b32 s48, v1
    s_and_b32 s49, s2, 1
    s_and_b32 s55, s2, -2
    s_lshl2_add_u32 s55, s55, s48
    s_mul_i32 s63, s49, 1280
    s_mul_i32 s73, s55, 2560
    s_add_u32 s73, s73, s63
    v_lshl_add_u32 v48, v254, 4, s73
    v_lshl_add_u32 v49, v254, 2, s73
    s_lshr_b32 s51, s2, 3
    s_bfe_u32 s50, s2, 0x20001
    s_lshl_b32 s54, s48, 10
    s_waitcnt lgkmcnt(0)
    global_load_dwordx4 v[40:43], v48, s[4:5]
    global_load_dword v44, v49, s[4:5] offset:1024
    s_cmp_ge_u32 s51, 14
    s_cbranch_scc1 .LtypeB
    s_cmp_ge_u32 s51, 7
    s_cselect_b32 s56, 1, 0
    s_cselect_b32 s57, 7, 0
    s_sub_u32 s53, s51, s57
    s_lshl_b32 s52, s50, 1
    s_add_u32 s52, s52, s56
    s_lshl3_add_u32 s56, s2, s48
    s_lshl_b32 s56, s56, 9
    v_lshrrev_b32 v76, 2, v254
    v_mul_u32_u24 v76, 458240, v76
    v_lshlrev_b32 v77, 7, v254
    v_add3_u32 v76, v76, v77, s56
    s_waitcnt lgkmcnt(0)
    s_mov_b32 s24, s4
    s_and_b32 s25, s5, 0xffff
    s_mov_b32 s26, 2621440
    s_mov_b32 s27, 0x20000
    s_mov_b32 s28, s6
    s_and_b32 s29, s7, 0xffff
    s_mov_b32 s30, 2457600
    s_mov_b32 s31, 0x20000
    s_mov_b32 exec_lo, 255
    s_mov_b32 exec_hi, 0
    buffer_load_dword v77, v76, s[28:31], 0 offen
    s_mov_b64 exec, -1
    v_lshrrev_b32 v80, 5, v254
    s_and_b32 s56, s48, 1
    s_lshl_b32 s56, s56, 1
    s_and_b32 s57, s48, 4
    s_or_b32 s56, s56, s57
    v_or_b32 v81, s56, v80
    v_bfe_u32 v82, v254, 1, 4
    v_xor_b32 v82, v82, v81
    v_mul_u32_u24 v83, 52, v82
    v_lshrrev_b32 v83, 8, v83
    v_mul_u32_u24 v84, 1120, v83
    v_lshl_add_u32 v84, v82, 5, v84
    v_and_b32 v83, 1, v254
    v_lshl_add_u32 v84, v83, 4, v84
    s_mul_i32 s56, s48, 7680
    s_mul_i32 s57, s52, 160
    s_add_u32 s56, s56, s57
    v_mul_u32_u24 v251, 3840, v80
    v_add3_u32 v251, v251, v84, s56
    v_mov_b32 v85, 2130706432
    v_cmp_gt_u32 vcc, 15, v82
    s_nop 1
    v_cndmask_b32 v251, v85, v251, vcc
    s_add_u32 m0, s54, 0
    s_mov_b32 s65, 0
    buffer_load_dwordx4 v251, s[28:31], s65 offen lds
    s_add_u32 m0, s54, 8192
    s_mov_b32 s65, 61440
    buffer_load_dwordx4 v251, s[28:31], s65 offen lds
    s_mul_i32 s63, s49, 1280
    s_mul_i32 s62, s53, 152
    s_sub_u32 s62, s62, 8
    v_lshrrev_b32 v80, 3, v254
    v_and_b32 v83, 7, v254
    s_mul_i32 s56, s48, 8
    s_add_u32 s56, s56, 0
    v_add_u32 v81, s56, v80
    v_add_u32 v84, s62, v81
    v_bfe_u32 v82, v81, 1, 3
    v_xor_b32 v82, v82, v83
    v_lshlrev_b32 v82, 4, v82
    v_mul_u32_u24 v252, 2560, v84
    v_add3_u32 v252, v252, v82, s63
    v_cmp_gt_u32 vcc, 1024, v84
    s_nop 1
    v_cndmask_b32 v252, v85, v252, vcc
    s_mul_i32 s56, s48, 8
    s_add_u32 s56, s56, 64
    v_add_u32 v81, s56, v80
    v_add_u32 v84, s62, v81
    v_mul_u32_u24 v253, 2560, v84
    v_add3_u32 v253, v253, v82, s63
    v_cmp_gt_u32 vcc, 1024, v84
    s_nop 1
    v_cndmask_b32 v253, v85, v253, vcc
    s_mul_i32 s56, s48, 4
    s_add_u32 s56, s56, 128
    v_add_u32 v81, s56, v80
    v_add_u32 v84, s62, v81
    v_bfe_u32 v82, v81, 1, 3
    v_xor_b32 v82, v82, v83
    v_lshlrev_b32 v82, 4, v82
    v_mul_u32_u24 v255, 2560, v84
    v_add3_u32 v255, v255, v82, s63
    v_cmp_gt_u32 vcc, 1024, v84
    s_nop 1
    v_cndmask_b32 v255, v85, v255, vcc
    s_mov_b32 s61, -1
    s_cmp_eq_u32 s48, 0
    s_cselect_b32 s60, 0xffffff00, -1
    s_lshl_b32 s75, s48, 9
    s_lshl_b32 s57, s49, 5
    s_add_u32 s56, s57, s53
    s_add_u32 s56, s56, 8
    s_lshl_b32 s56, s56, 8
    s_lshl_b32 s57, s52, 2
    s_add_u32 s56, s56, s57
    s_add_u32 s78, s56, 12599296
    s_mov_b32 s64, 0
    s_add_u32 m0, s54, 32768
    s_mov_b64 exec, s[60:61]
    buffer_load_dwordx4 v252, s[24:27], s64 offen lds
    s_mov_b64 exec, -1
    s_add_u32 m0, s54, 40960
    s_mov_b32 s64, 0
    buffer_load_dwordx4 v253, s[24:27], s64 offen lds
    s_mov_b32 s36, s22
    s_and_b32 s37, s23, 0xffff
    s_mov_b32 s38, 12845056
    s_mov_b32 s39, 0x20000
    s_mov_b32 s40, s20
    s_and_b32 s41, s21, 0xffff
    s_mov_b32 s42, 256
    s_mov_b32 s43, 0x20000
    s_or_b32 s56, s2, s48
    s_cbranch_scc1 .L1_para
    s_memrealtime s[56:57]
    s_waitcnt lgkmcnt(0)
    s_lshl_b32 s56, s56, 1
    s_or_b32 s56, s56, 1
    v_mov_b32 v72, s56
    s_mov_b64 exec, 1
    buffer_store_dword v72, off, s[40:43], 0 sc1
    s_mov_b64 exec, -1
.L1_para:
    s_mov_b32 s64, 0
    s_add_u32 m0, s75, 49152
    s_mov_b32 exec_hi, 0
    buffer_load_dwordx4 v255, s[24:27], s64 offen lds
    s_mov_b32 exec_hi, -1
    v_and_b32 v80, 15, v254
    v_lshrrev_b32 v81, 4, v254
    v_bfe_u32 v82, v254, 1, 3
    v_xor_b32 v82, v82, v81
    v_lshlrev_b32 v82, 4, v82
    v_lshl_or_b32 v248, v80, 7, v82
    v_xor_b32 v249, 64, v248
    v_bfe_u32 v82, v254, 2, 2
    v_lshl_add_u32 v83, v81, 3, v82
    v_lshlrev_b32 v250, 9, v83
    v_and_b32 v83, 1, v81
    v_lshl_or_b32 v82, v83, 2, v82
    v_xor_b32 v82, s48, v82
    v_lshl_add_u32 v250, v82, 5, v250
    v_and_b32 v82, 3, v254
    v_lshl_add_u32 v250, v82, 3, v250
    s_add_u32 m0, s54, 16384
    s_mov_b32 s65, 122880
    buffer_load_dwordx4 v251, s[28:31], s65 offen lds
    v_mov_b32 v80, 1065369472
    v_and_b32 v81, 31, v254
    v_lshlrev_b32 v81, 2, v81
    v_add_u32 v82, 53248, v81
    v_add_u32 v83, 106496, v81
    ds_write_b32 v81, v80 offset:32768
    ds_write_b32 v82, v80 offset:32768
    ds_write_b32 v83, v80 offset:32768
    v_mov_b32 v82, 0
    v_and_b32 v81, 15, v254
    v_lshlrev_b32 v81, 2, v81
    v_add_u32 v81, 163776, v81
    ds_write_b32 v81, v82
    s_lshr_b32 s58, s2, 2
    s_lshl_b32 s58, s58, 5
    s_waitcnt vmcnt(7)
    v_lshlrev_b32 v50, 16, v40
    s_add_u32 m0, s54, 24576
    s_mov_b32 s65, 184320
    buffer_load_dwordx4 v251, s[28:31], s65 offen lds
    s_and_b32 s57, s2, 3
    s_lshl_b32 s57, s57, 2
    v_and_b32 v51, 0xffff0000, v40
    s_add_u32 s58, s58, s57
    s_mov_b32 s57, 2130706432
    v_lshlrev_b32 v52, 16, v41
    s_cmp_eq_u32 s48, 0
    s_cselect_b32 s57, 12615680, s57
    s_cselect_b64 s[76:77], -1, 0
    v_lshl_add_u32 v88, v254, 5, s57
    v_and_b32 v53, 0xffff0000, v41
    s_and_b32 s56, s51, 3
    s_lshl_b32 s3, s50, 2
    v_lshlrev_b32 v54, 16, v42
    s_add_u32 s3, s3, s56
    s_lshl_b32 s56, s56, 1
    s_mov_b32 s64, 128
    s_add_u32 m0, s54, 86016
    s_mov_b64 exec, s[60:61]
    buffer_load_dwordx4 v252, s[24:27], s64 offen lds
    s_mov_b64 exec, -1
    v_and_b32 v55, 0xffff0000, v42
    s_lshr_b32 s1, s51, 2
    s_add_u32 s1, s1, s56
    v_lshlrev_b32 v56, 16, v43
    s_and_b32 s1, s1, 7
    v_and_b32 v57, 0xffff0000, v43
    s_mul_i32 s0, s48, 9
    s_mul_i32 s56, s48, 3
    v_lshlrev_b32 v58, 16, v44
    s_add_u32 s56, s56, 24
    s_min_u32 s0, s0, s56
    v_and_b32 v59, 0xffff0000, v44
    s_mul_i32 s79, s0, 40960
    s_mul_i32 s56, s1, 5120
    v_add_f32 v40, v50, v51
    s_add_u32 s79, s79, s56
    s_add_u32 s79, s79, 9437184
    s_add_u32 m0, s54, 53248
    s_mov_b32 s65, 245760
    buffer_load_dwordx4 v251, s[28:31], s65 offen lds
    v_add_f32 v41, v52, v53
    s_lshr_b32 s16, s3, 1
    s_mul_i32 s8, s16, 10
    v_add_f32 v42, v54, v55
    s_and_b32 s56, s3, 1
    s_lshl_b32 s56, s56, 1
    v_add_f32 v43, v56, v57
    s_add_u32 s8, s8, s56
    s_add_u32 s10, s8, 6
    v_add_f32 v44, v58, v59
    s_sub_u32 s56, s3, 12
    s_mul_i32 s57, s56, 20
    v_add_f32 v40, v40, v41
    s_add_u32 s57, s57, 4
    s_add_u32 s14, s57, 10
    v_add_f32 v42, v42, v43
    s_add_u32 m0, s54, 94208
    s_mov_b32 s64, 128
    buffer_load_dwordx4 v253, s[24:27], s64 offen lds
    s_lshl_b32 s56, s56, 1
    s_add_u32 s17, s56, 1
    v_add_f32 v40, v40, v44
    s_cmp_ge_u32 s3, 12
    s_cselect_b32 s8, s57, s8
    s_cselect_b32 s10, s14, s10
    s_cselect_b32 s17, s17, s16
    s_cselect_b32 s16, s56, s16
    v_add_f32 v66, v40, v42
    s_cmp_eq_u32 s3, 15
    s_cselect_b32 s8, 60, s8
    s_cselect_b32 s10, 62, s10
    s_cselect_b32 s16, 0, s16
    s_cselect_b32 s17, 5, s17
    v_add_f32_dpp v66, v66, v66 quad_perm:[1,0,3,2] row_mask:0xf bank_mask:0xf
    s_mul_i32 s14, s8, 54
    s_lshr_b32 s14, s14, 9
    s_add_u32 m0, s54, 61440
    s_mov_b32 s65, 307200
    buffer_load_dwordx4 v251, s[28:31], s65 offen lds
    v_add_f32_dpp v66, v66, v66 quad_perm:[2,3,0,1] row_mask:0xf bank_mask:0xf
    s_mul_i32 s21, s10, 54
    s_add_u32 s21, s21, 81
    v_add_f32_dpp v66, v66, v66 row_half_mirror row_mask:0xf bank_mask:0xf
    s_lshr_b32 s21, s21, 9
    s_nop 0
    v_add_f32_dpp v66, v66, v66 row_mirror row_mask:0xf bank_mask:0xf
    v_and_b32 v2, 15, v254
    s_nop 0
    v_add_f32_dpp v66, v66, v66 row_bcast:15 row_mask:0xa bank_mask:0xf
    v_lshrrev_b32 v3, 4, v254
    s_nop 0
    v_add_f32_dpp v66, v66, v66 row_bcast:31 row_mask:0xc bank_mask:0xf
    v_lshlrev_b32 v4, 2, v3
    v_mul_f32 v66, 0x3acccccd, v66
    v_sub_u32 v4, v2, v4
    v_readlane_b32 s22, v66, 63
    v_mov_b32 v5, 4048155338
    s_nop 0
    v_subrev_f32 v50, s22, v50
    s_mov_b32 s64, 128
    s_add_u32 m0, s75, 102400
    s_mov_b32 exec_hi, 0
    buffer_load_dwordx4 v255, s[24:27], s64 offen lds
    s_mov_b32 exec_hi, -1
    v_mov_b32 v7, 0xffff
    v_subrev_f32 v51, s22, v51
    v_add_u32 v6, 0, v4
    v_subrev_f32 v52, s22, v52
    v_cmp_gt_u32 vcc, 8, v6
    v_subrev_f32 v53, s22, v53
    v_ashrrev_i32 v8, 31, v6
    v_subrev_f32 v54, s22, v54
    v_add_u32 v6, 16, v6
    v_subrev_f32 v55, s22, v55
    v_cndmask_b32 v140, v5, 0, vcc
    v_subrev_f32 v56, s22, v56
    v_cmp_gt_u32 vcc, 8, v6
    v_subrev_f32 v57, s22, v57
    s_nop 0
    v_cndmask_b32 v144, v5, 0, vcc
    v_subrev_f32 v58, s22, v58
    s_add_u32 m0, s54, 69632
    s_mov_b32 s65, 368640
    buffer_load_dwordx4 v251, s[28:31], s65 offen lds
    v_add_u32 v6, -1, v4
    v_subrev_f32 v59, s22, v59
    v_cmp_gt_u32 vcc, 8, v6
    v_mul_f32 v66, v50, v50
    v_ashrrev_i32 v9, 31, v6
    v_mul_f32 v67, v51, v51
    v_add_u32 v6, 16, v6
    v_fmac_f32 v66, v52, v52
    v_cndmask_b32 v141, v5, 0, vcc
    v_fmac_f32 v67, v53, v53
    v_cmp_gt_u32 vcc, 8, v6
    v_fmac_f32 v66, v54, v54
    v_bfi_b32 v148, v7, v8, v9
    v_fmac_f32 v67, v55, v55
    v_cndmask_b32 v145, v5, 0, vcc
    v_fmac_f32 v66, v56, v56
    s_add_u32 m0, s54, 77824
    s_mov_b32 s65, 430080
    buffer_load_dwordx4 v251, s[28:31], s65 offen lds
    v_add_u32 v6, -2, v4
    v_fmac_f32 v67, v57, v57
    v_cmp_gt_u32 vcc, 8, v6
    v_fmac_f32 v66, v58, v58
    v_ashrrev_i32 v8, 31, v6
    v_fmac_f32 v67, v59, v59
    v_add_u32 v6, 16, v6
    v_add_f32 v66, v66, v67
    v_cndmask_b32 v142, v5, 0, vcc
    s_nop 0
    v_add_f32_dpp v66, v66, v66 quad_perm:[1,0,3,2] row_mask:0xf bank_mask:0xf
    v_cmp_gt_u32 vcc, 8, v6
    s_nop 0
    v_add_f32_dpp v66, v66, v66 quad_perm:[2,3,0,1] row_mask:0xf bank_mask:0xf
    v_cndmask_b32 v146, v5, 0, vcc
    s_nop 0
    v_add_f32_dpp v66, v66, v66 row_half_mirror row_mask:0xf bank_mask:0xf
    v_add_u32 v6, -3, v4
    s_nop 0
    v_add_f32_dpp v66, v66, v66 row_mirror row_mask:0xf bank_mask:0xf
    s_mov_b32 exec_lo, 3840
    s_mov_b32 exec_hi, 0
    buffer_load_dword v77, v76, s[28:31], 0 offen
    s_mov_b64 exec, -1
    v_cmp_gt_u32 vcc, 8, v6
    v_add_f32_dpp v66, v66, v66 row_bcast:15 row_mask:0xa bank_mask:0xf
    v_ashrrev_i32 v9, 31, v6
    s_nop 0
    v_add_f32_dpp v66, v66, v66 row_bcast:31 row_mask:0xc bank_mask:0xf
    v_add_u32 v6, 16, v6
    v_mul_f32 v66, 0x3acccccd, v66
    v_cndmask_b32 v143, v5, 0, vcc
    v_readlane_b32 s23, v66, 63
    v_cmp_gt_u32 vcc, 8, v6
    v_cvt_pk_bf16_f32 v68, s22, s22
    v_bfi_b32 v149, v7, v8, v9
    v_lshlrev_b32 v68, 16, v68
    v_cndmask_b32 v147, v5, 0, vcc
    v_sub_f32 v69, 0, v68
    s_lshr_b32 s56, s48, 1
    s_mul_i32 s66, s56, 3
    v_sub_f32 v68, 0, v68
    v_cvt_pk_bf16_f32 v66, s23, s23
    v_lshlrev_b32 v66, 16, v66
    v_add_f32 v66, 0x3727c5ac, v66
    v_cvt_pk_bf16_f32 v66, v66, v66
    v_lshlrev_b32 v66, 16, v66
    v_sqrt_f32 v66, v66
    s_nop 0
    v_cvt_pk_bf16_f32 v66, v66, v66
    v_lshlrev_b32 v66, 16, v66
    v_rcp_f32 v70, v66
    s_nop 0
    v_mul_f32 v71, v70, v70
    s_lshl_b32 s59, s49, 10
    s_add_u32 s55, s59, s55
    s_lshl_b32 s55, s55, 4
    s_add_u32 s55, s55, 12812288
    s_waitcnt vmcnt(8) lgkmcnt(0)
    s_barrier
    ds_read_b64_tr_b16 v[92:93], v250 offset:0
    ds_read_b64_tr_b16 v[94:95], v250 offset:2048
    ds_read_b64_tr_b16 v[96:97], v250 offset:256
    ds_read_b64_tr_b16 v[98:99], v250 offset:2304
    ds_read_b128 v[108:111], v248 offset:32768
    ds_read_b128 v[112:115], v248 offset:34816
    ds_read_b128 v[116:119], v248 offset:36864
    s_waitcnt lgkmcnt(2)
    v_mfma_f32_16x16x32_bf16 v[168:171], v[92:95], v[108:111], 0
    ds_read_b128 v[120:123], v248 offset:38912
    v_mfma_f32_16x16x32_bf16 v[172:175], v[96:99], v[108:111], 0
    ds_read_b128 v[124:127], v248 offset:40960
    s_mov_b64 exec, 1
    buffer_store_dwordx4 v[68:71], off, s[36:39], s55 sc1
    s_mov_b64 exec, -1
    s_waitcnt lgkmcnt(3)
    v_mfma_f32_16x16x32_bf16 v[176:179], v[92:95], v[112:115], 0
    ds_read_b128 v[128:131], v248 offset:43008
    v_mfma_f32_16x16x32_bf16 v[180:183], v[96:99], v[112:115], 0
    ds_read_b128 v[132:135], v248 offset:45056
    s_waitcnt lgkmcnt(3)
    v_mfma_f32_16x16x32_bf16 v[184:187], v[92:95], v[116:119], 0
    ds_read_b128 v[136:139], v248 offset:47104
    s_mov_b32 s64, 256
    s_add_u32 m0, s54, 139264
    s_mov_b64 exec, s[60:61]
    buffer_load_dwordx4 v252, s[24:27], s64 offen lds
    s_mov_b64 exec, -1
    v_mfma_f32_16x16x32_bf16 v[188:191], v[96:99], v[116:119], 0
    ds_read_b128 v[108:111], v248 offset:49152
    v_mfma_f32_16x16x32_bf16 v[192:195], v[92:95], v[120:123], 0
    ds_read_b128 v[112:115], v248 offset:51200
    v_mfma_f32_16x16x32_bf16 v[196:199], v[96:99], v[120:123], 0
    ds_read_b64_tr_b16 v[100:101], v250 offset:16384
    s_add_u32 m0, s54, 106496
    s_mov_b32 s65, 491520
    buffer_load_dwordx4 v251, s[28:31], s65 offen lds
    s_waitcnt lgkmcnt(5)
    v_mfma_f32_16x16x32_bf16 v[200:203], v[92:95], v[124:127], 0
    ds_read_b64_tr_b16 v[102:103], v250 offset:18432
    v_mfma_f32_16x16x32_bf16 v[204:207], v[96:99], v[124:127], 0
    ds_read_b64_tr_b16 v[104:105], v250 offset:16640
    v_mfma_f32_16x16x32_bf16 v[208:211], v[92:95], v[128:131], 0
    ds_read_b64_tr_b16 v[106:107], v250 offset:18688
    s_add_u32 m0, s54, 147456
    s_mov_b32 s64, 256
    buffer_load_dwordx4 v253, s[24:27], s64 offen lds
    v_mfma_f32_16x16x32_bf16 v[212:215], v[96:99], v[128:131], 0
    ds_read_b128 v[116:119], v249 offset:32768
    s_waitcnt lgkmcnt(7)
    v_mfma_f32_16x16x32_bf16 v[216:219], v[92:95], v[132:135], 0
    ds_read_b128 v[120:123], v249 offset:34816
    v_mfma_f32_16x16x32_bf16 v[220:223], v[96:99], v[132:135], 0
    ds_read_b128 v[124:127], v249 offset:36864
    s_add_u32 m0, s54, 114688
    s_mov_b32 s65, 552960
    buffer_load_dwordx4 v251, s[28:31], s65 offen lds
    v_mfma_f32_16x16x32_bf16 v[224:227], v[92:95], v[136:139], 0
    ds_read_b128 v[128:131], v249 offset:38912
    v_mfma_f32_16x16x32_bf16 v[228:231], v[96:99], v[136:139], 0
    ds_read_b128 v[132:135], v249 offset:40960
    s_waitcnt lgkmcnt(9)
    v_mfma_f32_16x16x32_bf16 v[232:235], v[92:95], v[108:111], 0
    ds_read_b128 v[136:139], v249 offset:43008
    s_mov_b32 s64, 256
    s_add_u32 m0, s75, 155648
    s_mov_b32 exec_hi, 0
    buffer_load_dwordx4 v255, s[24:27], s64 offen lds
    s_mov_b32 exec_hi, -1
    v_mfma_f32_16x16x32_bf16 v[236:239], v[96:99], v[108:111], 0
    ds_read_b128 v[108:111], v249 offset:45056
    v_mfma_f32_16x16x32_bf16 v[240:243], v[92:95], v[112:115], 0
    v_mfma_f32_16x16x32_bf16 v[244:247], v[96:99], v[112:115], 0
    ds_read_b128 v[112:115], v249 offset:47104
    s_add_u32 m0, s54, 122880
    s_mov_b32 s65, 614400
    buffer_load_dwordx4 v251, s[28:31], s65 offen lds
    s_waitcnt lgkmcnt(6)
    v_mfma_f32_16x16x32_bf16 v[168:171], v[100:103], v[116:119], v[168:171]
    v_mfma_f32_16x16x32_bf16 v[172:175], v[104:107], v[116:119], v[172:175]
    ds_read_b128 v[116:119], v249 offset:49152
    v_mfma_f32_16x16x32_bf16 v[176:179], v[100:103], v[120:123], v[176:179]
    s_add_u32 m0, s54, 131072
    s_mov_b32 s65, 675840
    buffer_load_dwordx4 v251, s[28:31], s65 offen lds
    v_mfma_f32_16x16x32_bf16 v[180:183], v[104:107], v[120:123], v[180:183]
    ds_read_b128 v[120:123], v249 offset:51200
    s_waitcnt lgkmcnt(6)
    v_mfma_f32_16x16x32_bf16 v[184:187], v[100:103], v[124:127], v[184:187]
    v_mfma_f32_16x16x32_bf16 v[188:191], v[104:107], v[124:127], v[188:191]
    v_mfma_f32_16x16x32_bf16 v[192:195], v[100:103], v[128:131], v[192:195]
    v_mfma_f32_16x16x32_bf16 v[196:199], v[104:107], v[128:131], v[196:199]
    s_waitcnt vmcnt(9) lgkmcnt(0)
    s_barrier
    v_mfma_f32_16x16x32_bf16 v[200:203], v[100:103], v[132:135], v[200:203]
    v_add_u32 v250, 53248, v250
    v_add_u32 v248, 53248, v248
    v_add_u32 v249, 53248, v249
    ds_read_b64_tr_b16 v[92:93], v250 offset:0
    v_mfma_f32_16x16x32_bf16 v[204:207], v[104:107], v[132:135], v[204:207]
    ds_read_b64_tr_b16 v[94:95], v250 offset:2048
    s_mov_b32 exec_lo, 16773120
    s_mov_b32 exec_hi, 0
    buffer_load_dword v77, v76, s[28:31], 0 offen
    s_mov_b64 exec, -1
    v_mfma_f32_16x16x32_bf16 v[208:211], v[100:103], v[136:139], v[208:211]
    ds_read_b64_tr_b16 v[96:97], v250 offset:256
    v_mfma_f32_16x16x32_bf16 v[212:215], v[104:107], v[136:139], v[212:215]
    ds_read_b64_tr_b16 v[98:99], v250 offset:2304
    v_mfma_f32_16x16x32_bf16 v[216:219], v[100:103], v[108:111], v[216:219]
    ds_read_b128 v[124:127], v248 offset:32768
    v_mfma_f32_16x16x32_bf16 v[220:223], v[104:107], v[108:111], v[220:223]
    ds_read_b128 v[128:131], v248 offset:34816
    v_mfma_f32_16x16x32_bf16 v[224:227], v[100:103], v[112:115], v[224:227]
    ds_read_b128 v[132:135], v248 offset:36864
    buffer_load_dword v84, off, s[40:43], 0 sc1
    v_mfma_f32_16x16x32_bf16 v[228:231], v[104:107], v[112:115], v[228:231]
    ds_read_b128 v[136:139], v248 offset:38912
    v_mfma_f32_16x16x32_bf16 v[232:235], v[100:103], v[116:119], v[232:235]
    ds_read_b128 v[108:111], v248 offset:40960
    v_mfma_f32_16x16x32_bf16 v[236:239], v[104:107], v[116:119], v[236:239]
    ds_read_b128 v[112:115], v248 offset:43008
    v_mfma_f32_16x16x32_bf16 v[240:243], v[100:103], v[120:123], v[240:243]
    ds_read_b128 v[116:119], v248 offset:45056
    v_mfma_f32_16x16x32_bf16 v[244:247], v[104:107], v[120:123], v[244:247]
    ds_read_b128 v[120:123], v248 offset:47104
    s_mov_b32 s64, 384
    s_add_u32 m0, s54, 32768
    s_mov_b64 exec, s[60:61]
    buffer_load_dwordx4 v252, s[24:27], s64 offen lds
    s_mov_b64 exec, -1
    s_waitcnt lgkmcnt(6)
    v_mfma_f32_16x16x32_bf16 v[168:171], v[92:95], v[124:127], v[168:171]
    v_mfma_f32_16x16x32_bf16 v[172:175], v[96:99], v[124:127], v[172:175]
    ds_read_b128 v[124:127], v248 offset:49152
    v_mfma_f32_16x16x32_bf16 v[176:179], v[92:95], v[128:131], v[176:179]
    v_mfma_f32_16x16x32_bf16 v[180:183], v[96:99], v[128:131], v[180:183]
    ds_read_b128 v[128:131], v248 offset:51200
    s_waitcnt lgkmcnt(6)
    v_mfma_f32_16x16x32_bf16 v[184:187], v[92:95], v[132:135], v[184:187]
    ds_read_b64_tr_b16 v[100:101], v250 offset:16384
    s_add_u32 m0, s54, 0
    s_mov_b32 s65, 737280
    buffer_load_dwordx4 v251, s[28:31], s65 offen lds
    v_mfma_f32_16x16x32_bf16 v[188:191], v[96:99], v[132:135], v[188:191]
    ds_read_b64_tr_b16 v[102:103], v250 offset:18432
    v_mfma_f32_16x16x32_bf16 v[192:195], v[92:95], v[136:139], v[192:195]
    ds_read_b64_tr_b16 v[104:105], v250 offset:16640
    v_mfma_f32_16x16x32_bf16 v[196:199], v[96:99], v[136:139], v[196:199]
    ds_read_b64_tr_b16 v[106:107], v250 offset:18688
    s_waitcnt lgkmcnt(8)
    v_mfma_f32_16x16x32_bf16 v[200:203], v[92:95], v[108:111], v[200:203]
    ds_read_b128 v[132:135], v249 offset:32768
    v_mfma_f32_16x16x32_bf16 v[204:207], v[96:99], v[108:111], v[204:207]
    ds_read_b128 v[136:139], v249 offset:34816
    s_add_u32 m0, s54, 40960
    s_mov_b32 s64, 384
    buffer_load_dwordx4 v253, s[24:27], s64 offen lds
    v_mfma_f32_16x16x32_bf16 v[208:211], v[92:95], v[112:115], v[208:211]
    ds_read_b128 v[108:111], v249 offset:36864
    v_mfma_f32_16x16x32_bf16 v[212:215], v[96:99], v[112:115], v[212:215]
    ds_read_b128 v[112:115], v249 offset:38912
    s_waitcnt lgkmcnt(10)
    v_mfma_f32_16x16x32_bf16 v[216:219], v[92:95], v[116:119], v[216:219]
    v_mfma_f32_16x16x32_bf16 v[220:223], v[96:99], v[116:119], v[220:223]
    ds_read_b128 v[116:119], v249 offset:40960
    v_mfma_f32_16x16x32_bf16 v[224:227], v[92:95], v[120:123], v[224:227]
    s_add_u32 m0, s54, 8192
    s_mov_b32 s65, 798720
    buffer_load_dwordx4 v251, s[28:31], s65 offen lds
    v_mfma_f32_16x16x32_bf16 v[228:231], v[96:99], v[120:123], v[228:231]
    ds_read_b128 v[120:123], v249 offset:43008
    s_waitcnt lgkmcnt(10)
    v_mfma_f32_16x16x32_bf16 v[232:235], v[92:95], v[124:127], v[232:235]
    v_mfma_f32_16x16x32_bf16 v[236:239], v[96:99], v[124:127], v[236:239]
    ds_read_b128 v[124:127], v249 offset:45056
    v_mfma_f32_16x16x32_bf16 v[240:243], v[92:95], v[128:131], v[240:243]
    v_mfma_f32_16x16x32_bf16 v[244:247], v[96:99], v[128:131], v[244:247]
    ds_read_b128 v[128:131], v249 offset:47104
    s_mov_b32 s64, 384
    s_add_u32 m0, s75, 49152
    s_mov_b32 exec_hi, 0
    buffer_load_dwordx4 v255, s[24:27], s64 offen lds
    s_mov_b32 exec_hi, -1
    s_waitcnt lgkmcnt(6)
    v_mfma_f32_16x16x32_bf16 v[168:171], v[100:103], v[132:135], v[168:171]
    v_mfma_f32_16x16x32_bf16 v[172:175], v[104:107], v[132:135], v[172:175]
    ds_read_b128 v[132:135], v249 offset:49152
    v_mfma_f32_16x16x32_bf16 v[176:179], v[100:103], v[136:139], v[176:179]
    v_mfma_f32_16x16x32_bf16 v[180:183], v[104:107], v[136:139], v[180:183]
    ds_read_b128 v[136:139], v249 offset:51200
    s_waitcnt lgkmcnt(6)
    v_mfma_f32_16x16x32_bf16 v[184:187], v[100:103], v[108:111], v[184:187]
    s_add_u32 m0, s54, 16384
    s_mov_b32 s65, 860160
    buffer_load_dwordx4 v251, s[28:31], s65 offen lds
    v_mfma_f32_16x16x32_bf16 v[188:191], v[104:107], v[108:111], v[188:191]
    v_mfma_f32_16x16x32_bf16 v[192:195], v[100:103], v[112:115], v[192:195]
    v_mfma_f32_16x16x32_bf16 v[196:199], v[104:107], v[112:115], v[196:199]
    s_add_u32 m0, s54, 24576
    s_mov_b32 s65, 921600
    buffer_load_dwordx4 v251, s[28:31], s65 offen lds
    s_waitcnt vmcnt(9) lgkmcnt(0)
    s_barrier
    v_mfma_f32_16x16x32_bf16 v[200:203], v[100:103], v[116:119], v[200:203]
    v_add_u32 v250, 53248, v250
    v_add_u32 v248, 53248, v248
    v_add_u32 v249, 53248, v249
    ds_read_b64_tr_b16 v[92:93], v250 offset:0
    v_mfma_f32_16x16x32_bf16 v[204:207], v[104:107], v[116:119], v[204:207]
    ds_read_b64_tr_b16 v[94:95], v250 offset:2048
    s_waitcnt vmcnt(7)
    v_readfirstlane_b32 s20, v84
    s_mov_b32 s59, 0
    s_cmp_eq_u32 s20, 0
    s_cbranch_scc1 .L2_para
.L3_para:
    s_mov_b64 exec, 1
    buffer_store_dword v84, v88, s[36:39], s58 offen sc1
    s_mov_b64 exec, -1
    v_mfma_f32_16x16x32_bf16 v[208:211], v[100:103], v[120:123], v[208:211]
    ds_read_b64_tr_b16 v[96:97], v250 offset:256
    v_mfma_f32_16x16x32_bf16 v[212:215], v[104:107], v[120:123], v[212:215]
    ds_read_b64_tr_b16 v[98:99], v250 offset:2304
    v_mfma_f32_16x16x32_bf16 v[216:219], v[100:103], v[124:127], v[216:219]
    ds_read_b128 v[108:111], v248 offset:32768
    v_mfma_f32_16x16x32_bf16 v[220:223], v[104:107], v[124:127], v[220:223]
    ds_read_b128 v[112:115], v248 offset:34816
    v_mfma_f32_16x16x32_bf16 v[224:227], v[100:103], v[128:131], v[224:227]
    ds_read_b128 v[116:119], v248 offset:36864
    s_mov_b32 s64, 512
    s_add_u32 m0, s54, 86016
    s_mov_b64 exec, s[60:61]
    buffer_load_dwordx4 v252, s[24:27], s64 offen lds
    s_mov_b64 exec, -1
    v_mfma_f32_16x16x32_bf16 v[228:231], v[104:107], v[128:131], v[228:231]
    ds_read_b128 v[120:123], v248 offset:38912
    v_mfma_f32_16x16x32_bf16 v[232:235], v[100:103], v[132:135], v[232:235]
    ds_read_b128 v[124:127], v248 offset:40960
    v_mfma_f32_16x16x32_bf16 v[236:239], v[104:107], v[132:135], v[236:239]
    ds_read_b128 v[128:131], v248 offset:43008
    v_mfma_f32_16x16x32_bf16 v[240:243], v[100:103], v[136:139], v[240:243]
    ds_read_b128 v[132:135], v248 offset:45056
    v_mfma_f32_16x16x32_bf16 v[244:247], v[104:107], v[136:139], v[244:247]
    ds_read_b128 v[136:139], v248 offset:47104
    s_add_u32 m0, s54, 53248
    s_mov_b32 s65, 983040
    buffer_load_dwordx4 v251, s[28:31], s65 offen lds
    s_waitcnt lgkmcnt(6)
    v_mfma_f32_16x16x32_bf16 v[168:171], v[92:95], v[108:111], v[168:171]
    v_mfma_f32_16x16x32_bf16 v[172:175], v[96:99], v[108:111], v[172:175]
    ds_read_b128 v[108:111], v248 offset:49152
    v_mfma_f32_16x16x32_bf16 v[176:179], v[92:95], v[112:115], v[176:179]
    v_mfma_f32_16x16x32_bf16 v[180:183], v[96:99], v[112:115], v[180:183]
    ds_read_b128 v[112:115], v248 offset:51200
    s_waitcnt lgkmcnt(6)
    v_mfma_f32_16x16x32_bf16 v[184:187], v[92:95], v[116:119], v[184:187]
    ds_read_b64_tr_b16 v[100:101], v250 offset:16384
    s_add_u32 m0, s54, 94208
    s_mov_b32 s64, 512
    buffer_load_dwordx4 v253, s[24:27], s64 offen lds
    v_mfma_f32_16x16x32_bf16 v[188:191], v[96:99], v[116:119], v[188:191]
    ds_read_b64_tr_b16 v[102:103], v250 offset:18432
    v_mfma_f32_16x16x32_bf16 v[192:195], v[92:95], v[120:123], v[192:195]
    ds_read_b64_tr_b16 v[104:105], v250 offset:16640
    v_mfma_f32_16x16x32_bf16 v[196:199], v[96:99], v[120:123], v[196:199]
    ds_read_b64_tr_b16 v[106:107], v250 offset:18688
    s_waitcnt lgkmcnt(8)
    v_mfma_f32_16x16x32_bf16 v[200:203], v[92:95], v[124:127], v[200:203]
    ds_read_b128 v[116:119], v249 offset:32768
    v_mfma_f32_16x16x32_bf16 v[204:207], v[96:99], v[124:127], v[204:207]
    ds_read_b128 v[120:123], v249 offset:34816
    s_add_u32 m0, s54, 61440
    s_mov_b32 s65, 1044480
    buffer_load_dwordx4 v251, s[28:31], s65 offen lds
    v_mfma_f32_16x16x32_bf16 v[208:211], v[92:95], v[128:131], v[208:211]
    ds_read_b128 v[124:127], v249 offset:36864
    v_mfma_f32_16x16x32_bf16 v[212:215], v[96:99], v[128:131], v[212:215]
    ds_read_b128 v[128:131], v249 offset:38912
    s_waitcnt lgkmcnt(10)
    v_mfma_f32_16x16x32_bf16 v[216:219], v[92:95], v[132:135], v[216:219]
    v_mfma_f32_16x16x32_bf16 v[220:223], v[96:99], v[132:135], v[220:223]
    ds_read_b128 v[132:135], v249 offset:40960
    v_mfma_f32_16x16x32_bf16 v[224:227], v[92:95], v[136:139], v[224:227]
    s_mov_b32 s64, 512
    s_add_u32 m0, s75, 102400
    s_mov_b32 exec_hi, 0
    buffer_load_dwordx4 v255, s[24:27], s64 offen lds
    s_mov_b32 exec_hi, -1
    v_mfma_f32_16x16x32_bf16 v[228:231], v[96:99], v[136:139], v[228:231]
    ds_read_b128 v[136:139], v249 offset:43008
    s_waitcnt lgkmcnt(10)
    v_mfma_f32_16x16x32_bf16 v[232:235], v[92:95], v[108:111], v[232:235]
    v_mfma_f32_16x16x32_bf16 v[236:239], v[96:99], v[108:111], v[236:239]
    ds_read_b128 v[108:111], v249 offset:45056
    v_mfma_f32_16x16x32_bf16 v[240:243], v[92:95], v[112:115], v[240:243]
    v_mfma_f32_16x16x32_bf16 v[244:247], v[96:99], v[112:115], v[244:247]
    ds_read_b128 v[112:115], v249 offset:47104
    s_add_u32 m0, s54, 69632
    s_mov_b32 s65, 1105920
    buffer_load_dwordx4 v251, s[28:31], s65 offen lds
    s_waitcnt lgkmcnt(6)
    v_mfma_f32_16x16x32_bf16 v[168:171], v[100:103], v[116:119], v[168:171]
    v_mfma_f32_16x16x32_bf16 v[172:175], v[104:107], v[116:119], v[172:175]
    ds_read_b128 v[116:119], v249 offset:49152
    v_mfma_f32_16x16x32_bf16 v[176:179], v[100:103], v[120:123], v[176:179]
    v_mfma_f32_16x16x32_bf16 v[180:183], v[104:107], v[120:123], v[180:183]
    ds_read_b128 v[120:123], v249 offset:51200
    s_waitcnt lgkmcnt(6)
    v_mfma_f32_16x16x32_bf16 v[184:187], v[100:103], v[124:127], v[184:187]
    s_add_u32 m0, s54, 77824
    s_mov_b32 s65, 1167360
    buffer_load_dwordx4 v251, s[28:31], s65 offen lds
    v_mfma_f32_16x16x32_bf16 v[188:191], v[104:107], v[124:127], v[188:191]
    v_mfma_f32_16x16x32_bf16 v[192:195], v[100:103], v[128:131], v[192:195]
    v_mfma_f32_16x16x32_bf16 v[196:199], v[104:107], v[128:131], v[196:199]
    s_waitcnt vmcnt(8) lgkmcnt(0)
    s_barrier
    v_mfma_f32_16x16x32_bf16 v[200:203], v[100:103], v[132:135], v[200:203]
    v_add_u32 v250, -106496, v250
    v_add_u32 v248, -106496, v248
    v_add_u32 v249, -106496, v249
    ds_read_b64_tr_b16 v[92:93], v250 offset:0
    s_min_u32 s66, s66, 8
    s_and_b32 s68, s48, 1
    v_mfma_f32_16x16x32_bf16 v[204:207], v[104:107], v[132:135], v[204:207]
    ds_read_b64_tr_b16 v[94:95], v250 offset:2048
    s_mov_b32 s64, 640
    s_add_u32 m0, s54, 139264
    s_mov_b64 exec, s[60:61]
    buffer_load_dwordx4 v252, s[24:27], s64 offen lds
    s_mov_b64 exec, -1
    v_mfma_f32_16x16x32_bf16 v[208:211], v[100:103], v[136:139], v[208:211]
    ds_read_b64_tr_b16 v[96:97], v250 offset:256
    s_mul_i32 s67, s66, 8448
    s_add_u32 s67, s67, 53248
    v_mfma_f32_16x16x32_bf16 v[212:215], v[104:107], v[136:139], v[212:215]
    ds_read_b64_tr_b16 v[98:99], v250 offset:2304
    s_mul_i32 s57, s68, 80
    s_add_u32 s69, s67, s57
    v_mul_u32_u24 v9, 528, v2
    v_mfma_f32_16x16x32_bf16 v[216:219], v[100:103], v[108:111], v[216:219]
    ds_read_b128 v[124:127], v248 offset:32768
    v_and_b32 v6, 8, v254
    v_mfma_f32_16x16x32_bf16 v[220:223], v[104:107], v[108:111], v[220:223]
    ds_read_b128 v[128:131], v248 offset:34816
    v_add_u32 v9, v9, v6
    v_mfma_f32_16x16x32_bf16 v[224:227], v[100:103], v[112:115], v[224:227]
    ds_read_b128 v[132:135], v248 offset:36864
    s_add_u32 m0, s54, 106496
    s_mov_b32 s65, 1228800
    buffer_load_dwordx4 v251, s[28:31], s65 offen lds
    v_mfma_f32_16x16x32_bf16 v[228:231], v[104:107], v[112:115], v[228:231]
    ds_read_b128 v[136:139], v248 offset:38912
    v_add_u32 v153, s69, v9
    v_mfma_f32_16x16x32_bf16 v[232:235], v[100:103], v[116:119], v[232:235]
    ds_read_b128 v[108:111], v248 offset:40960
    v_lshl_add_u32 v150, v3, 3, v153
    v_mfma_f32_16x16x32_bf16 v[236:239], v[104:107], v[116:119], v[236:239]
    ds_read_b128 v[112:115], v248 offset:43008
    v_add_u32 v7, s67, v9
    v_mfma_f32_16x16x32_bf16 v[240:243], v[100:103], v[120:123], v[240:243]
    ds_read_b128 v[116:119], v248 offset:45056
    v_add_u32 v7, 480, v7
    v_mfma_f32_16x16x32_bf16 v[244:247], v[104:107], v[120:123], v[244:247]
    ds_read_b128 v[120:123], v248 offset:47104
    s_add_u32 m0, s54, 147456
    s_mov_b32 s64, 640
    buffer_load_dwordx4 v253, s[24:27], s64 offen lds
    s_waitcnt lgkmcnt(6)
    v_mfma_f32_16x16x32_bf16 v[168:171], v[92:95], v[124:127], v[168:171]
    v_add_u32 v151, 32, v153
    v_mfma_f32_16x16x32_bf16 v[172:175], v[96:99], v[124:127], v[172:175]
    ds_read_b128 v[124:127], v248 offset:49152
    v_add_u32 v152, 72, v153
    v_mfma_f32_16x16x32_bf16 v[176:179], v[92:95], v[128:131], v[176:179]
    v_cmp_gt_u32 vcc, 16, v254
    v_mfma_f32_16x16x32_bf16 v[180:183], v[96:99], v[128:131], v[180:183]
    ds_read_b128 v[128:131], v248 offset:51200
    v_cndmask_b32 v151, v7, v151, vcc
    s_waitcnt lgkmcnt(6)
    v_mfma_f32_16x16x32_bf16 v[184:187], v[92:95], v[132:135], v[184:187]
    ds_read_b64_tr_b16 v[100:101], v250 offset:16384
    s_add_u32 m0, s54, 114688
    s_mov_b32 s65, 1290240
    buffer_load_dwordx4 v251, s[28:31], s65 offen lds
    v_mfma_f32_16x16x32_bf16 v[188:191], v[96:99], v[132:135], v[188:191]
    ds_read_b64_tr_b16 v[102:103], v250 offset:18432
    v_cndmask_b32 v152, v7, v152, vcc
    v_mfma_f32_16x16x32_bf16 v[192:195], v[92:95], v[136:139], v[192:195]
    ds_read_b64_tr_b16 v[104:105], v250 offset:16640
    v_lshl_add_u32 v164, v3, 3, v9
    v_mfma_f32_16x16x32_bf16 v[196:199], v[96:99], v[136:139], v[196:199]
    ds_read_b64_tr_b16 v[106:107], v250 offset:18688
    s_lshl_b32 s56, s48, 5
    s_add_u32 s56, s56, 61696
    v_add_u32 v164, s56, v164
    s_waitcnt lgkmcnt(8)
    v_mfma_f32_16x16x32_bf16 v[200:203], v[92:95], v[108:111], v[200:203]
    ds_read_b128 v[132:135], v249 offset:32768
    v_lshrrev_b32 v6, 2, v254
    v_mfma_f32_16x16x32_bf16 v[204:207], v[96:99], v[108:111], v[204:207]
    ds_read_b128 v[136:139], v249 offset:34816
    s_mov_b32 s64, 640
    s_add_u32 m0, s75, 155648
    s_mov_b32 exec_hi, 0
    buffer_load_dwordx4 v255, s[24:27], s64 offen lds
    s_mov_b32 exec_hi, -1
    v_mfma_f32_16x16x32_bf16 v[208:211], v[92:95], v[112:115], v[208:211]
    ds_read_b128 v[108:111], v249 offset:36864
    v_mul_u32_u24 v155, 528, v6
    v_mfma_f32_16x16x32_bf16 v[212:215], v[96:99], v[112:115], v[212:215]
    ds_read_b128 v[112:115], v249 offset:38912
    v_and_b32 v6, 8, v6
    s_waitcnt lgkmcnt(10)
    v_mfma_f32_16x16x32_bf16 v[216:219], v[92:95], v[116:119], v[216:219]
    v_add3_u32 v155, v155, v6, s69
    v_mfma_f32_16x16x32_bf16 v[220:223], v[96:99], v[116:119], v[220:223]
    ds_read_b128 v[116:119], v249 offset:40960
    v_and_b32 v6, 3, v254
    v_mfma_f32_16x16x32_bf16 v[224:227], v[92:95], v[120:123], v[224:227]
    s_add_u32 m0, s54, 122880
    s_mov_b32 s65, 1351680
    buffer_load_dwordx4 v251, s[28:31], s65 offen lds
    v_mfma_f32_16x16x32_bf16 v[228:231], v[96:99], v[120:123], v[228:231]
    ds_read_b128 v[120:123], v249 offset:43008
    v_lshl_add_u32 v154, v6, 3, v155
    s_waitcnt lgkmcnt(10)
    v_mfma_f32_16x16x32_bf16 v[232:235], v[92:95], v[124:127], v[232:235]
    s_lshl_b32 s56, s66, 4
    s_add_u32 s56, s56, s62
    v_add_u32 v12, s56, v2
    v_mfma_f32_16x16x32_bf16 v[236:239], v[96:99], v[124:127], v[236:239]
    ds_read_b128 v[124:127], v249 offset:45056
    v_add_u32 v6, 16, v12
    v_mfma_f32_16x16x32_bf16 v[240:243], v[92:95], v[128:131], v[240:243]
    v_lshrrev_b32 v6, 4, v6
    v_mfma_f32_16x16x32_bf16 v[244:247], v[96:99], v[128:131], v[244:247]
    ds_read_b128 v[128:131], v249 offset:47104
    s_add_u32 m0, s54, 131072
    s_mov_b32 s65, 1413120
    buffer_load_dwordx4 v251, s[28:31], s65 offen lds
    s_waitcnt lgkmcnt(6)
    v_mfma_f32_16x16x32_bf16 v[168:171], v[100:103], v[132:135], v[168:171]
    v_mul_u32_u24 v6, 69632, v6
    v_mfma_f32_16x16x32_bf16 v[172:175], v[104:107], v[132:135], v[172:175]
    ds_read_b128 v[132:135], v249 offset:49152
    v_and_b32 v7, 15, v12
    v_mfma_f32_16x16x32_bf16 v[176:179], v[100:103], v[136:139], v[176:179]
    v_lshl_add_u32 v6, v7, 4, v6
    v_mfma_f32_16x16x32_bf16 v[180:183], v[104:107], v[136:139], v[180:183]
    ds_read_b128 v[136:139], v249 offset:51200
    s_lshr_b32 s56, s52, 1
    s_mul_i32 s56, s56, 5
    s_waitcnt lgkmcnt(6)
    v_mfma_f32_16x16x32_bf16 v[184:187], v[100:103], v[108:111], v[184:187]
    s_add_u32 s56, s56, 48
    s_and_b32 s57, s52, 1
    v_mfma_f32_16x16x32_bf16 v[188:191], v[104:107], v[108:111], v[188:191]
    s_lshl_b32 s57, s57, 1
    s_add_u32 s57, s57, s68
    v_mfma_f32_16x16x32_bf16 v[192:195], v[100:103], v[112:115], v[192:195]
    s_add_u32 s70, s56, s57
    s_mul_i32 s70, s70, 1024
    v_mfma_f32_16x16x32_bf16 v[196:199], v[104:107], v[112:115], v[196:199]
    s_mul_i32 s71, s49, 4456448
    s_add_u32 s70, s70, s71
    s_waitcnt vmcnt(7) lgkmcnt(0)
    s_barrier
    v_mfma_f32_16x16x32_bf16 v[200:203], v[100:103], v[116:119], v[200:203]
    v_add_u32 v250, 53248, v250
    v_add_u32 v248, 53248, v248
    v_add_u32 v249, 53248, v249
    ds_read_b64_tr_b16 v[92:93], v250 offset:0
    s_add_u32 s73, s56, 4
    s_mul_i32 s73, s73, 1024
    v_mfma_f32_16x16x32_bf16 v[204:207], v[104:107], v[116:119], v[204:207]
    ds_read_b64_tr_b16 v[94:95], v250 offset:2048
    s_mov_b32 s64, 768
    s_add_u32 m0, s54, 32768
    s_mov_b64 exec, s[60:61]
    buffer_load_dwordx4 v252, s[24:27], s64 offen lds
    s_mov_b64 exec, -1
    v_mfma_f32_16x16x32_bf16 v[208:211], v[100:103], v[120:123], v[208:211]
    ds_read_b64_tr_b16 v[96:97], v250 offset:256
    s_add_u32 s73, s73, s71
    s_lshl_b32 s57, s57, 8
    v_mfma_f32_16x16x32_bf16 v[212:215], v[104:107], v[120:123], v[212:215]
    ds_read_b64_tr_b16 v[98:99], v250 offset:2304
    s_add_u32 s73, s73, s57
    v_lshl_add_u32 v6, v3, 8, v6
    v_mfma_f32_16x16x32_bf16 v[216:219], v[100:103], v[124:127], v[216:219]
    ds_read_b128 v[108:111], v248 offset:32768
    s_add_u32 s72, s62, 8
    v_subrev_u32 v12, s72, v12
    v_mfma_f32_16x16x32_bf16 v[220:223], v[104:107], v[124:127], v[220:223]
    ds_read_b128 v[112:115], v248 offset:34816
    s_sub_u32 s72, 1024, s72
    v_mov_b32 v159, 0x3ea52b5c
    v_mfma_f32_16x16x32_bf16 v[224:227], v[100:103], v[128:131], v[224:227]
    ds_read_b128 v[116:119], v248 offset:36864
    s_add_u32 m0, s54, 0
    s_mov_b32 s65, 1474560
    buffer_load_dwordx4 v251, s[28:31], s65 offen lds
    v_mfma_f32_16x16x32_bf16 v[228:231], v[104:107], v[128:131], v[228:231]
    ds_read_b128 v[120:123], v248 offset:38912
    v_mov_b32 v13, 2130706432
    v_mfma_f32_16x16x32_bf16 v[232:235], v[100:103], v[132:135], v[232:235]
    ds_read_b128 v[124:127], v248 offset:40960
    v_cmp_gt_u32 vcc, s72, v12
    v_mfma_f32_16x16x32_bf16 v[236:239], v[104:107], v[132:135], v[236:239]
    ds_read_b128 v[128:131], v248 offset:43008
    v_add_u32 v156, -69632, v6
    v_mfma_f32_16x16x32_bf16 v[240:243], v[100:103], v[136:139], v[240:243]
    ds_read_b128 v[132:135], v248 offset:45056
    v_add_u32 v12, 16, v12
    v_mfma_f32_16x16x32_bf16 v[244:247], v[104:107], v[136:139], v[244:247]
    ds_read_b128 v[136:139], v248 offset:47104
    s_add_u32 m0, s54, 40960
    s_mov_b32 s64, 768
    buffer_load_dwordx4 v253, s[24:27], s64 offen lds
    s_waitcnt lgkmcnt(6)
    v_mfma_f32_16x16x32_bf16 v[168:171], v[92:95], v[108:111], v[168:171]
    v_cndmask_b32 v156, v13, v156, vcc
    v_mfma_f32_16x16x32_bf16 v[172:175], v[96:99], v[108:111], v[172:175]
    ds_read_b128 v[108:111], v248 offset:49152
    v_cmp_gt_u32 vcc, s72, v12
    v_mfma_f32_16x16x32_bf16 v[176:179], v[92:95], v[112:115], v[176:179]
    v_add_u32 v157, 0, v6
    v_mfma_f32_16x16x32_bf16 v[180:183], v[96:99], v[112:115], v[180:183]
    ds_read_b128 v[112:115], v248 offset:51200
    v_add_u32 v12, 16, v12
    s_waitcnt lgkmcnt(6)
    v_mfma_f32_16x16x32_bf16 v[184:187], v[92:95], v[116:119], v[184:187]
    ds_read_b64_tr_b16 v[100:101], v250 offset:16384
    s_add_u32 m0, s54, 8192
    s_mov_b32 s65, 1536000
    buffer_load_dwordx4 v251, s[28:31], s65 offen lds
    v_mfma_f32_16x16x32_bf16 v[188:191], v[96:99], v[116:119], v[188:191]
    ds_read_b64_tr_b16 v[102:103], v250 offset:18432
    v_cndmask_b32 v157, v13, v157, vcc
    v_mfma_f32_16x16x32_bf16 v[192:195], v[92:95], v[120:123], v[192:195]
    ds_read_b64_tr_b16 v[104:105], v250 offset:16640
    v_cmp_gt_u32 vcc, s72, v12
    v_mfma_f32_16x16x32_bf16 v[196:199], v[96:99], v[120:123], v[196:199]
    ds_read_b64_tr_b16 v[106:107], v250 offset:18688
    v_add_u32 v158, 69632, v6
    s_waitcnt lgkmcnt(8)
    v_mfma_f32_16x16x32_bf16 v[200:203], v[92:95], v[124:127], v[200:203]
    ds_read_b128 v[116:119], v249 offset:32768
    v_add_u32 v12, 16, v12
    v_mfma_f32_16x16x32_bf16 v[204:207], v[96:99], v[124:127], v[204:207]
    ds_read_b128 v[120:123], v249 offset:34816
    s_mov_b32 s64, 768
    s_add_u32 m0, s75, 49152
    s_mov_b32 exec_hi, 0
    buffer_load_dwordx4 v255, s[24:27], s64 offen lds
    s_mov_b32 exec_hi, -1
    v_mfma_f32_16x16x32_bf16 v[208:211], v[92:95], v[128:131], v[208:211]
    ds_read_b128 v[124:127], v249 offset:36864
    v_cndmask_b32 v158, v13, v158, vcc
    v_mfma_f32_16x16x32_bf16 v[212:215], v[96:99], v[128:131], v[212:215]
    ds_read_b128 v[128:131], v249 offset:38912
    v_lshlrev_b32 v165, 4, v2
    s_waitcnt lgkmcnt(10)
    v_mfma_f32_16x16x32_bf16 v[216:219], v[92:95], v[132:135], v[216:219]
    v_add_u32 v165, 159744, v165
    v_mfma_f32_16x16x32_bf16 v[220:223], v[96:99], v[132:135], v[220:223]
    ds_read_b128 v[132:135], v249 offset:40960
    v_lshlrev_b32 v167, 4, v254
    v_mfma_f32_16x16x32_bf16 v[224:227], v[92:95], v[136:139], v[224:227]
    s_add_u32 m0, s54, 16384
    s_mov_b32 s65, 1597440
    buffer_load_dwordx4 v251, s[28:31], s65 offen lds
    v_mfma_f32_16x16x32_bf16 v[228:231], v[96:99], v[136:139], v[228:231]
    ds_read_b128 v[136:139], v249 offset:43008
    s_mul_i32 s56, s48, 20
    v_add_u32 v5, s56, v254
    s_waitcnt lgkmcnt(10)
    v_mfma_f32_16x16x32_bf16 v[232:235], v[92:95], v[108:111], v[232:235]
    v_add_u32 v6, s62, v5
    v_mfma_f32_16x16x32_bf16 v[236:239], v[96:99], v[108:111], v[236:239]
    ds_read_b128 v[108:111], v249 offset:45056
    s_lshl_b32 s56, s49, 14
    s_add_u32 s56, s56, 12812288
    v_lshl_add_u32 v166, v6, 4, s56
    v_mfma_f32_16x16x32_bf16 v[240:243], v[92:95], v[112:115], v[240:243]
    v_cmp_gt_u32 vcc, 1024, v6
    v_mfma_f32_16x16x32_bf16 v[244:247], v[96:99], v[112:115], v[244:247]
    ds_read_b128 v[112:115], v249 offset:47104
    s_add_u32 m0, s54, 24576
    s_mov_b32 s65, 1658880
    buffer_load_dwordx4 v251, s[28:31], s65 offen lds
    s_waitcnt lgkmcnt(6)
    v_mfma_f32_16x16x32_bf16 v[168:171], v[100:103], v[116:119], v[168:171]
    v_cndmask_b32 v166, v13, v166, vcc
    v_mfma_f32_16x16x32_bf16 v[172:175], v[104:107], v[116:119], v[172:175]
    ds_read_b128 v[116:119], v249 offset:49152
    v_cmp_lt_u32 vcc, 0, v5
    v_mfma_f32_16x16x32_bf16 v[176:179], v[100:103], v[120:123], v[176:179]
    s_nop 0
    v_cndmask_b32 v166, v13, v166, vcc
    v_mfma_f32_16x16x32_bf16 v[180:183], v[104:107], v[120:123], v[180:183]
    ds_read_b128 v[120:123], v249 offset:51200
    s_mul_i32 s74, s48, 320
    s_add_u32 s74, s74, 159744
    s_waitcnt lgkmcnt(6)
    v_mfma_f32_16x16x32_bf16 v[184:187], v[100:103], v[124:127], v[184:187]
    s_cmp_eq_u32 s66, 0
    s_cselect_b32 s67, 4048155338, 0
    v_mfma_f32_16x16x32_bf16 v[188:191], v[104:107], v[124:127], v[188:191]
    s_cmp_eq_u32 s53, 0
    s_cselect_b32 s68, s67, 0
    v_mfma_f32_16x16x32_bf16 v[192:195], v[100:103], v[128:131], v[192:195]
    s_mul_i32 s71, s48, 5120
    s_mov_b32 s56, 136192
    v_mfma_f32_16x16x32_bf16 v[196:199], v[104:107], v[128:131], v[196:199]
    s_cmp_lt_u32 s48, 2
    s_cselect_b32 s72, 40960, s56
    s_waitcnt vmcnt(7) lgkmcnt(0)
    s_barrier
    v_mfma_f32_16x16x32_bf16 v[200:203], v[100:103], v[132:135], v[200:203]
    v_add_u32 v250, 53248, v250
    v_add_u32 v248, 53248, v248
    v_add_u32 v249, 53248, v249
    ds_read_b64_tr_b16 v[92:93], v250 offset:0
    s_add_u32 s72, s72, s71
    v_mfma_f32_16x16x32_bf16 v[204:207], v[104:107], v[132:135], v[204:207]
    ds_read_b64_tr_b16 v[94:95], v250 offset:2048
    s_mov_b32 s64, 896
    s_add_u32 m0, s54, 86016
    s_mov_b64 exec, s[60:61]
    buffer_load_dwordx4 v252, s[24:27], s64 offen lds
    s_mov_b64 exec, -1
    v_mfma_f32_16x16x32_bf16 v[208:211], v[100:103], v[136:139], v[208:211]
    ds_read_b64_tr_b16 v[96:97], v250 offset:256
    v_bfe_u32 v5, v254, 2, 3
    v_mfma_f32_16x16x32_bf16 v[212:215], v[104:107], v[136:139], v[212:215]
    ds_read_b64_tr_b16 v[98:99], v250 offset:2304
    v_add_u32 v5, s16, v5
    v_mfma_f32_16x16x32_bf16 v[216:219], v[100:103], v[108:111], v[216:219]
    ds_read_b128 v[124:127], v248 offset:32768
    v_min_u32 v5, s17, v5
    v_mfma_f32_16x16x32_bf16 v[220:223], v[104:107], v[108:111], v[220:223]
    ds_read_b128 v[128:131], v248 offset:34816
    v_and_b32 v6, 3, v254
    v_mfma_f32_16x16x32_bf16 v[224:227], v[100:103], v[112:115], v[224:227]
    ds_read_b128 v[132:135], v248 offset:36864
    s_add_u32 m0, s54, 53248
    s_mov_b32 s65, 1720320
    buffer_load_dwordx4 v251, s[28:31], s65 offen lds
    v_mfma_f32_16x16x32_bf16 v[228:231], v[104:107], v[112:115], v[228:231]
    ds_read_b128 v[136:139], v248 offset:38912
    v_min_u32 v6, 2, v6
    v_mfma_f32_16x16x32_bf16 v[232:235], v[100:103], v[116:119], v[232:235]
    ds_read_b128 v[108:111], v248 offset:40960
    v_lshlrev_b32 v5, 8, v5
    v_mfma_f32_16x16x32_bf16 v[236:239], v[104:107], v[116:119], v[236:239]
    ds_read_b128 v[112:115], v248 offset:43008
    v_lshl_add_u32 v160, v6, 4, v5
    v_mfma_f32_16x16x32_bf16 v[240:243], v[100:103], v[120:123], v[240:243]
    ds_read_b128 v[116:119], v248 offset:45056
    s_lshl_b32 s15, s49, 13
    s_add_u32 s15, s15, 12599296
    v_mfma_f32_16x16x32_bf16 v[244:247], v[104:107], v[120:123], v[244:247]
    ds_read_b128 v[120:123], v248 offset:47104
    s_add_u32 m0, s54, 94208
    s_mov_b32 s64, 896
    buffer_load_dwordx4 v253, s[24:27], s64 offen lds
    s_waitcnt lgkmcnt(6)
    v_mfma_f32_16x16x32_bf16 v[168:171], v[92:95], v[124:127], v[168:171]
    s_lshl_b32 s56, s49, 4
    s_add_u32 s56, s56, s3
    v_mfma_f32_16x16x32_bf16 v[172:175], v[96:99], v[124:127], v[172:175]
    ds_read_b128 v[124:127], v248 offset:49152
    s_mul_i32 s56, s56, 4352
    s_add_u32 s56, s56, 12652032
    v_lshl_add_u32 v5, v6, 4, s56
    v_mfma_f32_16x16x32_bf16 v[176:179], v[92:95], v[128:131], v[176:179]
    v_add_u32 v160, s15, v160
    v_mfma_f32_16x16x32_bf16 v[180:183], v[96:99], v[128:131], v[180:183]
    ds_read_b128 v[128:131], v248 offset:51200
    v_cmp_gt_u32 vcc, 32, v254
    s_waitcnt lgkmcnt(6)
    v_mfma_f32_16x16x32_bf16 v[184:187], v[92:95], v[132:135], v[184:187]
    ds_read_b64_tr_b16 v[100:101], v250 offset:16384
    s_add_u32 m0, s54, 61440
    s_mov_b32 s65, 1781760
    buffer_load_dwordx4 v251, s[28:31], s65 offen lds
    v_mfma_f32_16x16x32_bf16 v[188:191], v[96:99], v[132:135], v[188:191]
    ds_read_b64_tr_b16 v[102:103], v250 offset:18432
    v_cndmask_b32 v160, v5, v160, vcc
    v_mfma_f32_16x16x32_bf16 v[192:195], v[92:95], v[136:139], v[192:195]
    ds_read_b64_tr_b16 v[104:105], v250 offset:16640
    s_mul_i32 s12, s0, 1024
    s_mul_i32 s56, s49, 4456448
    v_mfma_f32_16x16x32_bf16 v[196:199], v[96:99], v[136:139], v[196:199]
    ds_read_b64_tr_b16 v[106:107], v250 offset:18688
    s_add_u32 s12, s12, s56
    s_mul_i32 s13, s49, 1280
    s_waitcnt lgkmcnt(8)
    v_mfma_f32_16x16x32_bf16 v[200:203], v[92:95], v[108:111], v[200:203]
    ds_read_b128 v[132:135], v249 offset:32768
    s_mul_i32 s56, s1, 160
    s_add_u32 s13, s13, s56
    v_mfma_f32_16x16x32_bf16 v[204:207], v[96:99], v[108:111], v[204:207]
    ds_read_b128 v[136:139], v249 offset:34816
    s_mov_b32 s64, 896
    s_add_u32 m0, s75, 102400
    s_mov_b32 exec_hi, 0
    buffer_load_dwordx4 v255, s[24:27], s64 offen lds
    s_mov_b32 exec_hi, -1
    v_mfma_f32_16x16x32_bf16 v[208:211], v[92:95], v[112:115], v[208:211]
    ds_read_b128 v[108:111], v249 offset:36864
    s_lshl_b32 s56, s49, 14
    s_add_u32 s56, s56, 12812300
    v_mfma_f32_16x16x32_bf16 v[212:215], v[96:99], v[112:115], v[212:215]
    ds_read_b128 v[112:115], v249 offset:38912
    s_lshl_b32 s55, s10, 8
    s_add_u32 s55, s55, s56
    s_waitcnt lgkmcnt(10)
    v_mfma_f32_16x16x32_bf16 v[216:219], v[92:95], v[116:119], v[216:219]
    s_lshl_b32 s57, s8, 8
    s_add_u32 s62, s57, s56
    v_mfma_f32_16x16x32_bf16 v[220:223], v[96:99], v[116:119], v[220:223]
    ds_read_b128 v[116:119], v249 offset:40960
    s_mul_i32 s57, s8, 69632
    s_add_u32 s4, s12, s57
    v_mfma_f32_16x16x32_bf16 v[224:227], v[92:95], v[120:123], v[224:227]
    s_add_u32 m0, s54, 69632
    s_mov_b32 s65, 1843200
    buffer_load_dwordx4 v251, s[28:31], s65 offen lds
    v_mfma_f32_16x16x32_bf16 v[228:231], v[96:99], v[120:123], v[228:231]
    ds_read_b128 v[120:123], v249 offset:43008
    s_add_u32 s5, s4, 69632
    s_mul_i32 s57, s8, 40960
    s_waitcnt lgkmcnt(10)
    v_mfma_f32_16x16x32_bf16 v[232:235], v[92:95], v[124:127], v[232:235]
    s_add_u32 s8, s13, s57
    s_add_u32 s9, s8, 40960
    v_mfma_f32_16x16x32_bf16 v[236:239], v[96:99], v[124:127], v[236:239]
    ds_read_b128 v[124:127], v249 offset:45056
    s_mul_i32 s57, s10, 69632
    s_add_u32 s6, s12, s57
    v_mfma_f32_16x16x32_bf16 v[240:243], v[92:95], v[128:131], v[240:243]
    s_add_u32 s7, s6, 69632
    s_mul_i32 s57, s10, 40960
    v_mfma_f32_16x16x32_bf16 v[244:247], v[96:99], v[128:131], v[244:247]
    ds_read_b128 v[128:131], v249 offset:47104
    s_add_u32 m0, s54, 77824
    s_mov_b32 s65, 1904640
    buffer_load_dwordx4 v251, s[28:31], s65 offen lds
    s_waitcnt lgkmcnt(6)
    v_mfma_f32_16x16x32_bf16 v[168:171], v[100:103], v[132:135], v[168:171]
    s_add_u32 s10, s13, s57
    s_add_u32 s11, s10, 40960
    v_mfma_f32_16x16x32_bf16 v[172:175], v[104:107], v[132:135], v[172:175]
    ds_read_b128 v[132:135], v249 offset:49152
    s_mov_b32 s13, s62
    v_mfma_f32_16x16x32_bf16 v[176:179], v[100:103], v[136:139], v[176:179]
    s_lshl_b32 s56, s48, 1
    s_add_u32 s56, s56, 4
    v_mfma_f32_16x16x32_bf16 v[180:183], v[104:107], v[136:139], v[180:183]
    ds_read_b128 v[136:139], v249 offset:51200
    s_cmp_lt_u32 s48, 4
    s_cselect_b32 s56, 3, s56
    s_cselect_b32 s57, 3072, 0
    s_cselect_b32 s1, s4, s5
    s_waitcnt lgkmcnt(6)
    v_mfma_f32_16x16x32_bf16 v[184:187], v[100:103], v[108:111], v[184:187]
    s_add_u32 s1, s1, s57
    s_mul_i32 s58, s56, 1024
    v_mfma_f32_16x16x32_bf16 v[188:191], v[104:107], v[108:111], v[188:191]
    s_mul_i32 s56, s56, 40960
    s_add_u32 s0, s79, s56
    v_mfma_f32_16x16x32_bf16 v[192:195], v[100:103], v[112:115], v[192:195]
    v_mfma_f32_16x16x32_bf16 v[196:199], v[104:107], v[112:115], v[196:199]
    s_waitcnt vmcnt(7) lgkmcnt(0)
    s_barrier
    v_mfma_f32_16x16x32_bf16 v[200:203], v[100:103], v[116:119], v[200:203]
    v_add_u32 v250, -106496, v250
    v_add_u32 v248, -106496, v248
    v_add_u32 v249, -106496, v249
    ds_read_b64_tr_b16 v[92:93], v250 offset:0
    v_mfma_f32_16x16x32_bf16 v[204:207], v[104:107], v[116:119], v[204:207]
    ds_read_b64_tr_b16 v[94:95], v250 offset:2048
    s_mov_b32 s64, 1024
    s_add_u32 m0, s54, 139264
    s_mov_b64 exec, s[60:61]
    buffer_load_dwordx4 v252, s[24:27], s64 offen lds
    s_mov_b64 exec, -1
    v_mfma_f32_16x16x32_bf16 v[208:211], v[100:103], v[120:123], v[208:211]
    ds_read_b64_tr_b16 v[96:97], v250 offset:256
    v_mfma_f32_16x16x32_bf16 v[212:215], v[104:107], v[120:123], v[212:215]
    ds_read_b64_tr_b16 v[98:99], v250 offset:2304
    v_mfma_f32_16x16x32_bf16 v[216:219], v[100:103], v[124:127], v[216:219]
    ds_read_b128 v[108:111], v248 offset:32768
    v_mfma_f32_16x16x32_bf16 v[220:223], v[104:107], v[124:127], v[220:223]
    ds_read_b128 v[112:115], v248 offset:34816
    v_mfma_f32_16x16x32_bf16 v[224:227], v[100:103], v[128:131], v[224:227]
    ds_read_b128 v[116:119], v248 offset:36864
    s_add_u32 m0, s54, 106496
    s_mov_b32 s65, 1966080
    buffer_load_dwordx4 v251, s[28:31], s65 offen lds
    v_mfma_f32_16x16x32_bf16 v[228:231], v[104:107], v[128:131], v[228:231]
    ds_read_b128 v[120:123], v248 offset:38912
    v_mfma_f32_16x16x32_bf16 v[232:235], v[100:103], v[132:135], v[232:235]
    ds_read_b128 v[124:127], v248 offset:40960
    v_mfma_f32_16x16x32_bf16 v[236:239], v[104:107], v[132:135], v[236:239]
    ds_read_b128 v[128:131], v248 offset:43008
    v_mfma_f32_16x16x32_bf16 v[240:243], v[100:103], v[136:139], v[240:243]
    ds_read_b128 v[132:135], v248 offset:45056
    v_mfma_f32_16x16x32_bf16 v[244:247], v[104:107], v[136:139], v[244:247]
    ds_read_b128 v[136:139], v248 offset:47104
    s_add_u32 m0, s54, 147456
    s_mov_b32 s64, 1024
    buffer_load_dwordx4 v253, s[24:27], s64 offen lds
    s_waitcnt lgkmcnt(6)
    v_mfma_f32_16x16x32_bf16 v[168:171], v[92:95], v[108:111], v[168:171]
    v_mfma_f32_16x16x32_bf16 v[172:175], v[96:99], v[108:111], v[172:175]
    ds_read_b128 v[108:111], v248 offset:49152
    v_mfma_f32_16x16x32_bf16 v[176:179], v[92:95], v[112:115], v[176:179]
    v_mfma_f32_16x16x32_bf16 v[180:183], v[96:99], v[112:115], v[180:183]
    ds_read_b128 v[112:115], v248 offset:51200
    s_waitcnt lgkmcnt(6)
    v_mfma_f32_16x16x32_bf16 v[184:187], v[92:95], v[116:119], v[184:187]
    ds_read_b64_tr_b16 v[100:101], v250 offset:16384
    s_add_u32 m0, s54, 114688
    s_mov_b32 s65, 2027520
    buffer_load_dwordx4 v251, s[28:31], s65 offen lds
    v_mfma_f32_16x16x32_bf16 v[188:191], v[96:99], v[116:119], v[188:191]
    ds_read_b64_tr_b16 v[102:103], v250 offset:18432
    v_mfma_f32_16x16x32_bf16 v[192:195], v[92:95], v[120:123], v[192:195]
    ds_read_b64_tr_b16 v[104:105], v250 offset:16640
    v_mfma_f32_16x16x32_bf16 v[196:199], v[96:99], v[120:123], v[196:199]
    ds_read_b64_tr_b16 v[106:107], v250 offset:18688
    s_waitcnt lgkmcnt(8)
    v_mfma_f32_16x16x32_bf16 v[200:203], v[92:95], v[124:127], v[200:203]
    ds_read_b128 v[116:119], v249 offset:32768
    v_mfma_f32_16x16x32_bf16 v[204:207], v[96:99], v[124:127], v[204:207]
    ds_read_b128 v[120:123], v249 offset:34816
    s_mov_b32 s64, 1024
    s_add_u32 m0, s75, 155648
    s_mov_b32 exec_hi, 0
    buffer_load_dwordx4 v255, s[24:27], s64 offen lds
    s_mov_b32 exec_hi, -1
    v_mfma_f32_16x16x32_bf16 v[208:211], v[92:95], v[128:131], v[208:211]
    ds_read_b128 v[124:127], v249 offset:36864
    v_mfma_f32_16x16x32_bf16 v[212:215], v[96:99], v[128:131], v[212:215]
    ds_read_b128 v[128:131], v249 offset:38912
    s_waitcnt lgkmcnt(10)
    v_mfma_f32_16x16x32_bf16 v[216:219], v[92:95], v[132:135], v[216:219]
    v_mfma_f32_16x16x32_bf16 v[220:223], v[96:99], v[132:135], v[220:223]
    ds_read_b128 v[132:135], v249 offset:40960
    v_mfma_f32_16x16x32_bf16 v[224:227], v[92:95], v[136:139], v[224:227]
    s_add_u32 m0, s54, 122880
    s_mov_b32 s65, 2088960
    buffer_load_dwordx4 v251, s[28:31], s65 offen lds
    v_mfma_f32_16x16x32_bf16 v[228:231], v[96:99], v[136:139], v[228:231]
    ds_read_b128 v[136:139], v249 offset:43008
    s_waitcnt lgkmcnt(10)
    v_mfma_f32_16x16x32_bf16 v[232:235], v[92:95], v[108:111], v[232:235]
    v_mfma_f32_16x16x32_bf16 v[236:239], v[96:99], v[108:111], v[236:239]
    ds_read_b128 v[108:111], v249 offset:45056
    v_mfma_f32_16x16x32_bf16 v[240:243], v[92:95], v[112:115], v[240:243]
    v_mfma_f32_16x16x32_bf16 v[244:247], v[96:99], v[112:115], v[244:247]
    ds_read_b128 v[112:115], v249 offset:47104
    s_add_u32 m0, s54, 131072
    s_mov_b32 s65, 2150400
    buffer_load_dwordx4 v251, s[28:31], s65 offen lds
    s_waitcnt lgkmcnt(6)
    v_mfma_f32_16x16x32_bf16 v[168:171], v[100:103], v[116:119], v[168:171]
    v_mfma_f32_16x16x32_bf16 v[172:175], v[104:107], v[116:119], v[172:175]
    ds_read_b128 v[116:119], v249 offset:49152
    v_mfma_f32_16x16x32_bf16 v[176:179], v[100:103], v[120:123], v[176:179]
    v_mfma_f32_16x16x32_bf16 v[180:183], v[104:107], v[120:123], v[180:183]
    ds_read_b128 v[120:123], v249 offset:51200
    s_waitcnt lgkmcnt(6)
    v_mfma_f32_16x16x32_bf16 v[184:187], v[100:103], v[124:127], v[184:187]
    v_mfma_f32_16x16x32_bf16 v[188:191], v[104:107], v[124:127], v[188:191]
    v_mfma_f32_16x16x32_bf16 v[192:195], v[100:103], v[128:131], v[192:195]
    v_mfma_f32_16x16x32_bf16 v[196:199], v[104:107], v[128:131], v[196:199]
    s_waitcnt vmcnt(7) lgkmcnt(0)
    s_barrier
    v_mfma_f32_16x16x32_bf16 v[200:203], v[100:103], v[132:135], v[200:203]
    v_add_u32 v250, 53248, v250
    v_add_u32 v248, 53248, v248
    v_add_u32 v249, 53248, v249
    ds_read_b64_tr_b16 v[92:93], v250 offset:0
    v_mfma_f32_16x16x32_bf16 v[204:207], v[104:107], v[132:135], v[204:207]
    ds_read_b64_tr_b16 v[94:95], v250 offset:2048
    buffer_load_dwordx4 v[84:87], v88, s[36:39], 0 offen sc1
    v_mfma_f32_16x16x32_bf16 v[208:211], v[100:103], v[136:139], v[208:211]
    ds_read_b64_tr_b16 v[96:97], v250 offset:256
    v_mfma_f32_16x16x32_bf16 v[212:215], v[104:107], v[136:139], v[212:215]
    ds_read_b64_tr_b16 v[98:99], v250 offset:2304
    v_mfma_f32_16x16x32_bf16 v[216:219], v[100:103], v[108:111], v[216:219]
    ds_read_b128 v[124:127], v248 offset:32768
    v_mfma_f32_16x16x32_bf16 v[220:223], v[104:107], v[108:111], v[220:223]
    ds_read_b128 v[128:131], v248 offset:34816
    v_mfma_f32_16x16x32_bf16 v[224:227], v[100:103], v[112:115], v[224:227]
    ds_read_b128 v[132:135], v248 offset:36864
    s_mov_b32 s64, 1152
    s_add_u32 m0, s54, 32768
    s_mov_b64 exec, s[60:61]
    buffer_load_dwordx4 v252, s[24:27], s64 offen lds
    s_mov_b64 exec, -1
    v_mfma_f32_16x16x32_bf16 v[228:231], v[104:107], v[112:115], v[228:231]
    ds_read_b128 v[136:139], v248 offset:38912
    v_mfma_f32_16x16x32_bf16 v[232:235], v[100:103], v[116:119], v[232:235]
    ds_read_b128 v[108:111], v248 offset:40960
    v_mfma_f32_16x16x32_bf16 v[236:239], v[104:107], v[116:119], v[236:239]
    ds_read_b128 v[112:115], v248 offset:43008
    v_mfma_f32_16x16x32_bf16 v[240:243], v[100:103], v[120:123], v[240:243]
    ds_read_b128 v[116:119], v248 offset:45056
    v_mfma_f32_16x16x32_bf16 v[244:247], v[104:107], v[120:123], v[244:247]
    ds_read_b128 v[120:123], v248 offset:47104
    s_add_u32 m0, s54, 0
    s_mov_b32 s65, 2211840
    buffer_load_dwordx4 v251, s[28:31], s65 offen lds
    s_waitcnt lgkmcnt(6)
    v_mfma_f32_16x16x32_bf16 v[168:171], v[92:95], v[124:127], v[168:171]
    v_mfma_f32_16x16x32_bf16 v[172:175], v[96:99], v[124:127], v[172:175]
    ds_read_b128 v[124:127], v248 offset:49152
    v_mfma_f32_16x16x32_bf16 v[176:179], v[92:95], v[128:131], v[176:179]
    v_mfma_f32_16x16x32_bf16 v[180:183], v[96:99], v[128:131], v[180:183]
    ds_read_b128 v[128:131], v248 offset:51200
    s_waitcnt lgkmcnt(6)
    v_mfma_f32_16x16x32_bf16 v[184:187], v[92:95], v[132:135], v[184:187]
    ds_read_b64_tr_b16 v[100:101], v250 offset:16384
    s_add_u32 m0, s54, 40960
    s_mov_b32 s64, 1152
    buffer_load_dwordx4 v253, s[24:27], s64 offen lds
    v_mfma_f32_16x16x32_bf16 v[188:191], v[96:99], v[132:135], v[188:191]
    ds_read_b64_tr_b16 v[102:103], v250 offset:18432
    v_mfma_f32_16x16x32_bf16 v[192:195], v[92:95], v[136:139], v[192:195]
    ds_read_b64_tr_b16 v[104:105], v250 offset:16640
    v_mfma_f32_16x16x32_bf16 v[196:199], v[96:99], v[136:139], v[196:199]
    ds_read_b64_tr_b16 v[106:107], v250 offset:18688
    s_waitcnt lgkmcnt(8)
    v_mfma_f32_16x16x32_bf16 v[200:203], v[92:95], v[108:111], v[200:203]
    ds_read_b128 v[132:135], v249 offset:32768
    v_mfma_f32_16x16x32_bf16 v[204:207], v[96:99], v[108:111], v[204:207]
    ds_read_b128 v[136:139], v249 offset:34816
    s_add_u32 m0, s54, 8192
    s_mov_b32 s65, 2273280
    buffer_load_dwordx4 v251, s[28:31], s65 offen lds
    v_mfma_f32_16x16x32_bf16 v[208:211], v[92:95], v[112:115], v[208:211]
    ds_read_b128 v[108:111], v249 offset:36864
    v_mfma_f32_16x16x32_bf16 v[212:215], v[96:99], v[112:115], v[212:215]
    ds_read_b128 v[112:115], v249 offset:38912
    s_waitcnt lgkmcnt(10)
    v_mfma_f32_16x16x32_bf16 v[216:219], v[92:95], v[116:119], v[216:219]
    v_mfma_f32_16x16x32_bf16 v[220:223], v[96:99], v[116:119], v[220:223]
    ds_read_b128 v[116:119], v249 offset:40960
    v_mfma_f32_16x16x32_bf16 v[224:227], v[92:95], v[120:123], v[224:227]
    s_mov_b32 s64, 1152
    s_add_u32 m0, s75, 49152
    s_mov_b32 exec_hi, 0
    buffer_load_dwordx4 v255, s[24:27], s64 offen lds
    s_mov_b32 exec_hi, -1
    v_mfma_f32_16x16x32_bf16 v[228:231], v[96:99], v[120:123], v[228:231]
    ds_read_b128 v[120:123], v249 offset:43008
    s_waitcnt lgkmcnt(10)
    v_mfma_f32_16x16x32_bf16 v[232:235], v[92:95], v[124:127], v[232:235]
    v_mfma_f32_16x16x32_bf16 v[236:239], v[96:99], v[124:127], v[236:239]
    ds_read_b128 v[124:127], v249 offset:45056
    v_mfma_f32_16x16x32_bf16 v[240:243], v[92:95], v[128:131], v[240:243]
    v_mfma_f32_16x16x32_bf16 v[244:247], v[96:99], v[128:131], v[244:247]
    ds_read_b128 v[128:131], v249 offset:47104
    s_add_u32 m0, s54, 16384
    s_mov_b32 s65, 2334720
    buffer_load_dwordx4 v251, s[28:31], s65 offen lds
    s_waitcnt lgkmcnt(6)
    v_mfma_f32_16x16x32_bf16 v[168:171], v[100:103], v[132:135], v[168:171]
    v_mfma_f32_16x16x32_bf16 v[172:175], v[104:107], v[132:135], v[172:175]
    ds_read_b128 v[132:135], v249 offset:49152
    v_mfma_f32_16x16x32_bf16 v[176:179], v[100:103], v[136:139], v[176:179]
    v_mfma_f32_16x16x32_bf16 v[180:183], v[104:107], v[136:139], v[180:183]
    ds_read_b128 v[136:139], v249 offset:51200
    s_waitcnt lgkmcnt(6)
    v_mfma_f32_16x16x32_bf16 v[184:187], v[100:103], v[108:111], v[184:187]
    s_add_u32 m0, s54, 24576
    s_mov_b32 s65, 2396160
    buffer_load_dwordx4 v251, s[28:31], s65 offen lds
    v_mfma_f32_16x16x32_bf16 v[188:191], v[104:107], v[108:111], v[188:191]
    v_mfma_f32_16x16x32_bf16 v[192:195], v[100:103], v[112:115], v[192:195]
    v_mfma_f32_16x16x32_bf16 v[196:199], v[104:107], v[112:115], v[196:199]
    s_waitcnt vmcnt(7)
    v_xor_b32 v84, s20, v84
    v_xor_b32 v85, s20, v85
    v_xor_b32 v86, s20, v86
    v_xor_b32 v87, s20, v87
    v_or_b32 v84, v84, v85
    v_or3_b32 v84, v84, v86, v87
    v_cmp_ne_u32 vcc, 0, v84
    s_nop 0
    s_and_b64 vcc, vcc, s[76:77]
    s_mov_b32 s59, 0
    s_cbranch_vccnz .L4_para
.L5_para:
    s_waitcnt lgkmcnt(0)
    s_barrier
    v_mfma_f32_16x16x32_bf16 v[200:203], v[100:103], v[116:119], v[200:203]
    v_add_u32 v250, 53248, v250
    v_add_u32 v248, 53248, v248
    v_add_u32 v249, 53248, v249
    ds_read_b64_tr_b16 v[92:93], v250 offset:0
    v_mfma_f32_16x16x32_bf16 v[204:207], v[104:107], v[116:119], v[204:207]
    ds_read_b64_tr_b16 v[94:95], v250 offset:2048
    s_mov_b32 m0, s74
    s_mov_b64 exec, 0xfffff
    buffer_load_dwordx4 v166, s[36:39], 0 offen sc1 lds
    s_mov_b64 exec, -1
    v_mfma_f32_16x16x32_bf16 v[208:211], v[100:103], v[120:123], v[208:211]
    ds_read_b64_tr_b16 v[96:97], v250 offset:256
    v_mfma_f32_16x16x32_bf16 v[212:215], v[104:107], v[120:123], v[212:215]
    ds_read_b64_tr_b16 v[98:99], v250 offset:2304
    v_mfma_f32_16x16x32_bf16 v[216:219], v[100:103], v[124:127], v[216:219]
    ds_read_b128 v[108:111], v248 offset:32768
    v_mfma_f32_16x16x32_bf16 v[220:223], v[104:107], v[124:127], v[220:223]
    ds_read_b128 v[112:115], v248 offset:34816
    s_add_u32 s64, s79, 0
    buffer_load_dwordx4 v[0:3], v167, s[36:39], s64 offen offset:0 sc1
    v_mfma_f32_16x16x32_bf16 v[224:227], v[100:103], v[128:131], v[224:227]
    ds_read_b128 v[116:119], v248 offset:36864
    v_mfma_f32_16x16x32_bf16 v[228:231], v[104:107], v[128:131], v[228:231]
    ds_read_b128 v[120:123], v248 offset:38912
    v_mfma_f32_16x16x32_bf16 v[232:235], v[100:103], v[132:135], v[232:235]
    ds_read_b128 v[124:127], v248 offset:40960
    v_mfma_f32_16x16x32_bf16 v[236:239], v[104:107], v[132:135], v[236:239]
    ds_read_b128 v[128:131], v248 offset:43008
    s_add_u32 s64, s79, 0
    buffer_load_dwordx4 v[4:7], v167, s[36:39], s64 offen offset:1024 sc1
    v_mfma_f32_16x16x32_bf16 v[240:243], v[100:103], v[136:139], v[240:243]
    ds_read_b128 v[132:135], v248 offset:45056
    v_mfma_f32_16x16x32_bf16 v[244:247], v[104:107], v[136:139], v[244:247]
    ds_read_b128 v[136:139], v248 offset:47104
    s_waitcnt lgkmcnt(6)
    v_mfma_f32_16x16x32_bf16 v[168:171], v[92:95], v[108:111], v[168:171]
    v_mfma_f32_16x16x32_bf16 v[172:175], v[96:99], v[108:111], v[172:175]
    ds_read_b128 v[108:111], v248 offset:49152
    s_add_u32 s64, s79, 0
    buffer_load_dwordx4 v[8:11], v167, s[36:39], s64 offen offset:2048 sc1
    v_mfma_f32_16x16x32_bf16 v[176:179], v[92:95], v[112:115], v[176:179]
    v_mfma_f32_16x16x32_bf16 v[180:183], v[96:99], v[112:115], v[180:183]
    ds_read_b128 v[112:115], v248 offset:51200
    s_waitcnt lgkmcnt(6)
    v_mfma_f32_16x16x32_bf16 v[184:187], v[92:95], v[116:119], v[184:187]
    ds_read_b64_tr_b16 v[100:101], v250 offset:16384
    v_mfma_f32_16x16x32_bf16 v[188:191], v[96:99], v[116:119], v[188:191]
    ds_read_b64_tr_b16 v[102:103], v250 offset:18432
    s_add_u32 s64, s79, 0
    buffer_load_dwordx4 v[12:15], v167, s[36:39], s64 offen offset:3072 sc1
    v_mfma_f32_16x16x32_bf16 v[192:195], v[92:95], v[120:123], v[192:195]
    ds_read_b64_tr_b16 v[104:105], v250 offset:16640
    v_mfma_f32_16x16x32_bf16 v[196:199], v[96:99], v[120:123], v[196:199]
    ds_read_b64_tr_b16 v[106:107], v250 offset:18688
    s_waitcnt lgkmcnt(8)
    v_mfma_f32_16x16x32_bf16 v[200:203], v[92:95], v[124:127], v[200:203]
    ds_read_b128 v[116:119], v249 offset:32768
    v_mfma_f32_16x16x32_bf16 v[204:207], v[96:99], v[124:127], v[204:207]
    ds_read_b128 v[120:123], v249 offset:34816
    s_add_u32 s64, s79, 4096
    buffer_load_dwordx4 v[16:19], v167, s[36:39], s64 offen offset:0 sc1
    v_mfma_f32_16x16x32_bf16 v[208:211], v[92:95], v[128:131], v[208:211]
    ds_read_b128 v[124:127], v249 offset:36864
    v_mfma_f32_16x16x32_bf16 v[212:215], v[96:99], v[128:131], v[212:215]
    ds_read_b128 v[128:131], v249 offset:38912
    s_waitcnt lgkmcnt(10)
    v_mfma_f32_16x16x32_bf16 v[216:219], v[92:95], v[132:135], v[216:219]
    v_mfma_f32_16x16x32_bf16 v[220:223], v[96:99], v[132:135], v[220:223]
    ds_read_b128 v[132:135], v249 offset:40960
    s_add_u32 s64, s79, 40960
    buffer_load_dwordx4 v[20:23], v167, s[36:39], s64 offen offset:0 sc1
    v_mfma_f32_16x16x32_bf16 v[224:227], v[92:95], v[136:139], v[224:227]
    v_mfma_f32_16x16x32_bf16 v[228:231], v[96:99], v[136:139], v[228:231]
    ds_read_b128 v[136:139], v249 offset:43008
    s_waitcnt lgkmcnt(10)
    v_mfma_f32_16x16x32_bf16 v[232:235], v[92:95], v[108:111], v[232:235]
    v_mfma_f32_16x16x32_bf16 v[236:239], v[96:99], v[108:111], v[236:239]
    ds_read_b128 v[108:111], v249 offset:45056
    s_add_u32 s64, s79, 40960
    buffer_load_dwordx4 v[24:27], v167, s[36:39], s64 offen offset:1024 sc1
    v_mfma_f32_16x16x32_bf16 v[240:243], v[92:95], v[112:115], v[240:243]
    v_mfma_f32_16x16x32_bf16 v[244:247], v[96:99], v[112:115], v[244:247]
    ds_read_b128 v[112:115], v249 offset:47104
    s_waitcnt lgkmcnt(6)
    v_mfma_f32_16x16x32_bf16 v[168:171], v[100:103], v[116:119], v[168:171]
    v_mfma_f32_16x16x32_bf16 v[172:175], v[104:107], v[116:119], v[172:175]
    ds_read_b128 v[116:119], v249 offset:49152
    s_add_u32 s64, s79, 40960
    buffer_load_dwordx4 v[28:31], v167, s[36:39], s64 offen offset:2048 sc1
    v_mfma_f32_16x16x32_bf16 v[176:179], v[100:103], v[120:123], v[176:179]
    v_mfma_f32_16x16x32_bf16 v[180:183], v[104:107], v[120:123], v[180:183]
    ds_read_b128 v[120:123], v249 offset:51200
    s_waitcnt lgkmcnt(6)
    v_mfma_f32_16x16x32_bf16 v[184:187], v[100:103], v[124:127], v[184:187]
    v_mfma_f32_16x16x32_bf16 v[188:191], v[104:107], v[124:127], v[188:191]
    s_add_u32 s64, s79, 40960
    buffer_load_dwordx4 v[32:35], v167, s[36:39], s64 offen offset:3072 sc1
    v_mfma_f32_16x16x32_bf16 v[192:195], v[100:103], v[128:131], v[192:195]
    v_mfma_f32_16x16x32_bf16 v[196:199], v[104:107], v[128:131], v[196:199]
    s_waitcnt vmcnt(9) lgkmcnt(0)
    s_barrier
    v_mfma_f32_16x16x32_bf16 v[200:203], v[100:103], v[132:135], v[200:203]
    v_add_u32 v250, -106496, v250
    v_add_u32 v248, -106496, v248
    v_add_u32 v249, -106496, v249
    ds_read_b64_tr_b16 v[92:93], v250 offset:0
    v_mfma_f32_16x16x32_bf16 v[204:207], v[104:107], v[132:135], v[204:207]
    ds_read_b64_tr_b16 v[94:95], v250 offset:2048
    s_add_u32 s64, s79, 45056
    buffer_load_dwordx4 v[36:39], v167, s[36:39], s64 offen offset:0 sc1
    v_mfma_f32_16x16x32_bf16 v[208:211], v[100:103], v[136:139], v[208:211]
    ds_read_b64_tr_b16 v[96:97], v250 offset:256
    v_mfma_f32_16x16x32_bf16 v[212:215], v[104:107], v[136:139], v[212:215]
    ds_read_b64_tr_b16 v[98:99], v250 offset:2304
    v_mfma_f32_16x16x32_bf16 v[216:219], v[100:103], v[108:111], v[216:219]
    ds_read_b128 v[124:127], v248 offset:32768
    v_mfma_f32_16x16x32_bf16 v[220:223], v[104:107], v[108:111], v[220:223]
    ds_read_b128 v[128:131], v248 offset:34816
    s_add_u32 s64, s79, 81920
    buffer_load_dwordx4 v[40:43], v167, s[36:39], s64 offen offset:0 sc1
    v_mfma_f32_16x16x32_bf16 v[224:227], v[100:103], v[112:115], v[224:227]
    ds_read_b128 v[132:135], v248 offset:36864
    v_mfma_f32_16x16x32_bf16 v[228:231], v[104:107], v[112:115], v[228:231]
    ds_read_b128 v[136:139], v248 offset:38912
    v_mfma_f32_16x16x32_bf16 v[232:235], v[100:103], v[116:119], v[232:235]
    ds_read_b128 v[108:111], v248 offset:40960
    v_mfma_f32_16x16x32_bf16 v[236:239], v[104:107], v[116:119], v[236:239]
    ds_read_b128 v[112:115], v248 offset:43008
    s_add_u32 s64, s79, 81920
    buffer_load_dwordx4 v[44:47], v167, s[36:39], s64 offen offset:1024 sc1
    v_mfma_f32_16x16x32_bf16 v[240:243], v[100:103], v[120:123], v[240:243]
    ds_read_b128 v[116:119], v248 offset:45056
    v_mfma_f32_16x16x32_bf16 v[244:247], v[104:107], v[120:123], v[244:247]
    ds_read_b128 v[120:123], v248 offset:47104
    s_waitcnt lgkmcnt(6)
    v_mfma_f32_16x16x32_bf16 v[168:171], v[92:95], v[124:127], v[168:171]
    v_mfma_f32_16x16x32_bf16 v[172:175], v[96:99], v[124:127], v[172:175]
    ds_read_b128 v[124:127], v248 offset:49152
    s_add_u32 s64, s79, 81920
    buffer_load_dwordx4 v[48:51], v167, s[36:39], s64 offen offset:2048 sc1
    v_mfma_f32_16x16x32_bf16 v[176:179], v[92:95], v[128:131], v[176:179]
    v_mfma_f32_16x16x32_bf16 v[180:183], v[96:99], v[128:131], v[180:183]
    ds_read_b128 v[128:131], v248 offset:51200
    s_waitcnt lgkmcnt(6)
    v_mfma_f32_16x16x32_bf16 v[184:187], v[92:95], v[132:135], v[184:187]
    ds_read_b64_tr_b16 v[100:101], v250 offset:16384
    v_mfma_f32_16x16x32_bf16 v[188:191], v[96:99], v[132:135], v[188:191]
    ds_read_b64_tr_b16 v[102:103], v250 offset:18432
    s_add_u32 s64, s79, 81920
    buffer_load_dwordx4 v[52:55], v167, s[36:39], s64 offen offset:3072 sc1
    v_mfma_f32_16x16x32_bf16 v[192:195], v[92:95], v[136:139], v[192:195]
    ds_read_b64_tr_b16 v[104:105], v250 offset:16640
    v_mfma_f32_16x16x32_bf16 v[196:199], v[96:99], v[136:139], v[196:199]
    ds_read_b64_tr_b16 v[106:107], v250 offset:18688
    s_waitcnt lgkmcnt(8)
    v_mfma_f32_16x16x32_bf16 v[200:203], v[92:95], v[108:111], v[200:203]
    ds_read_b128 v[132:135], v249 offset:32768
    v_mfma_f32_16x16x32_bf16 v[204:207], v[96:99], v[108:111], v[204:207]
    ds_read_b128 v[136:139], v249 offset:34816
    s_add_u32 s64, s79, 86016
    buffer_load_dwordx4 v[56:59], v167, s[36:39], s64 offen offset:0 sc1
    v_mfma_f32_16x16x32_bf16 v[208:211], v[92:95], v[112:115], v[208:211]
    ds_read_b128 v[108:111], v249 offset:36864
    v_mfma_f32_16x16x32_bf16 v[212:215], v[96:99], v[112:115], v[212:215]
    ds_read_b128 v[112:115], v249 offset:38912
    s_waitcnt lgkmcnt(10)
    v_mfma_f32_16x16x32_bf16 v[216:219], v[92:95], v[116:119], v[216:219]
    v_mfma_f32_16x16x32_bf16 v[220:223], v[96:99], v[116:119], v[220:223]
    ds_read_b128 v[116:119], v249 offset:40960
    s_add_u32 s64, s0, 0
    buffer_load_dwordx4 v[60:63], v167, s[36:39], s64 offen offset:0 sc1
    v_mfma_f32_16x16x32_bf16 v[224:227], v[92:95], v[120:123], v[224:227]
    v_mfma_f32_16x16x32_bf16 v[228:231], v[96:99], v[120:123], v[228:231]
    ds_read_b128 v[120:123], v249 offset:43008
    s_waitcnt lgkmcnt(10)
    v_mfma_f32_16x16x32_bf16 v[232:235], v[92:95], v[124:127], v[232:235]
    v_mfma_f32_16x16x32_bf16 v[236:239], v[96:99], v[124:127], v[236:239]
    ds_read_b128 v[124:127], v249 offset:45056
    s_add_u32 s64, s0, 0
    buffer_load_dwordx4 v[64:67], v167, s[36:39], s64 offen offset:1024 sc1
    v_mfma_f32_16x16x32_bf16 v[240:243], v[92:95], v[128:131], v[240:243]
    v_mfma_f32_16x16x32_bf16 v[244:247], v[96:99], v[128:131], v[244:247]
    ds_read_b128 v[128:131], v249 offset:47104
    s_waitcnt lgkmcnt(6)
    v_mfma_f32_16x16x32_bf16 v[168:171], v[100:103], v[132:135], v[168:171]
    v_mfma_f32_16x16x32_bf16 v[172:175], v[104:107], v[132:135], v[172:175]
    ds_read_b128 v[132:135], v249 offset:49152
    s_add_u32 s64, s0, 0
    buffer_load_dwordx4 v[68:71], v167, s[36:39], s64 offen offset:2048 sc1
    v_mfma_f32_16x16x32_bf16 v[176:179], v[100:103], v[136:139], v[176:179]
    v_mfma_f32_16x16x32_bf16 v[180:183], v[104:107], v[136:139], v[180:183]
    ds_read_b128 v[136:139], v249 offset:51200
    s_waitcnt lgkmcnt(6)
    v_mfma_f32_16x16x32_bf16 v[184:187], v[100:103], v[108:111], v[184:187]
    v_mfma_f32_16x16x32_bf16 v[188:191], v[104:107], v[108:111], v[188:191]
    s_add_u32 s64, s0, 0
    buffer_load_dwordx4 v[72:75], v167, s[36:39], s64 offen offset:3072 sc1
    v_mfma_f32_16x16x32_bf16 v[192:195], v[100:103], v[112:115], v[192:195]
    v_mfma_f32_16x16x32_bf16 v[196:199], v[104:107], v[112:115], v[196:199]
    s_waitcnt lgkmcnt(4)
    v_mfma_f32_16x16x32_bf16 v[200:203], v[100:103], v[116:119], v[200:203]
    v_mfma_f32_16x16x32_bf16 v[204:207], v[104:107], v[116:119], v[204:207]
    s_add_u32 s64, s0, 4096
    buffer_load_dwordx4 v[76:79], v167, s[36:39], s64 offen offset:0 sc1
    v_mfma_f32_16x16x32_bf16 v[208:211], v[100:103], v[120:123], v[208:211]
    v_mfma_f32_16x16x32_bf16 v[212:215], v[104:107], v[120:123], v[212:215]
    s_waitcnt lgkmcnt(2)
    v_mfma_f32_16x16x32_bf16 v[216:219], v[100:103], v[124:127], v[216:219]
    v_mfma_f32_16x16x32_bf16 v[220:223], v[104:107], v[124:127], v[220:223]
    s_add_u32 s64, s0, 40960
    buffer_load_dwordx4 v[80:83], v167, s[36:39], s64 offen offset:0 sc1
    v_mfma_f32_16x16x32_bf16 v[224:227], v[100:103], v[128:131], v[224:227]
    v_mfma_f32_16x16x32_bf16 v[228:231], v[104:107], v[128:131], v[228:231]
    s_waitcnt lgkmcnt(1)
    v_mfma_f32_16x16x32_bf16 v[232:235], v[100:103], v[132:135], v[232:235]
    v_mfma_f32_16x16x32_bf16 v[236:239], v[104:107], v[132:135], v[236:239]
    s_waitcnt lgkmcnt(0)
    v_mfma_f32_16x16x32_bf16 v[240:243], v[100:103], v[136:139], v[240:243]
    v_mfma_f32_16x16x32_bf16 v[244:247], v[104:107], v[136:139], v[244:247]
    ds_read_b128 v[124:127], v165 offset:0
    ds_read_b128 v[128:131], v165 offset:256
    v_mov_b32_dpp v116, v168 row_newbcast:0 row_mask:0xf bank_mask:0xf
    v_mov_b32_dpp v117, v169 row_newbcast:0 row_mask:0xf bank_mask:0xf
    v_mov_b32_dpp v118, v170 row_newbcast:0 row_mask:0xf bank_mask:0xf
    v_mov_b32_dpp v119, v171 row_newbcast:0 row_mask:0xf bank_mask:0xf
    v_mov_b32_dpp v120, v172 row_newbcast:0 row_mask:0xf bank_mask:0xf
    v_mov_b32_dpp v121, v173 row_newbcast:0 row_mask:0xf bank_mask:0xf
    v_mov_b32_dpp v122, v174 row_newbcast:0 row_mask:0xf bank_mask:0xf
    v_mov_b32_dpp v123, v175 row_newbcast:0 row_mask:0xf bank_mask:0xf
    v_add_u32 v248, 59136, v164
    v_mov_b32 v253, v167
    v_mov_b32 v252, v160
    s_waitcnt lgkmcnt(1)
    v_fmac_f32 v168, v116, v125
    v_fmac_f32 v169, v117, v124
    v_fmac_f32 v170, v118, v125
    v_fmac_f32 v171, v119, v124
    v_fmac_f32 v172, v120, v125
    v_fmac_f32 v173, v121, v124
    v_fmac_f32 v174, v122, v125
    v_fmac_f32 v175, v123, v124
    v_mul_f32 v168, v168, v126
    v_mul_f32 v169, v169, v126
    v_mul_f32 v170, v170, v126
    v_mul_f32 v171, v171, v126
    v_mul_f32 v172, v172, v126
    v_mul_f32 v173, v173, v126
    v_mul_f32 v174, v174, v126
    v_mul_f32 v175, v175, v126
    ds_read_b128 v[124:127], v165 offset:512
    v_cvt_pk_bf16_f32 v132, v168, v169
    v_cvt_pk_bf16_f32 v133, v170, v171
    ds_write_b64 v164, v[132:133] offset:0
    v_cvt_pk_bf16_f32 v134, v172, v173
    v_cvt_pk_bf16_f32 v135, v174, v175
    ds_write_b64 v164, v[134:135] offset:256
    s_add_u32 s64, s0, 40960
    buffer_load_dwordx4 v[84:87], v253, s[36:39], s64 offen offset:1024 sc1
    s_waitcnt lgkmcnt(3)
    v_fmac_f32 v176, v116, v129
    v_fmac_f32 v177, v117, v128
    v_fmac_f32 v178, v118, v129
    v_fmac_f32 v179, v119, v128
    v_fmac_f32 v180, v120, v129
    v_fmac_f32 v181, v121, v128
    v_fmac_f32 v182, v122, v129
    v_fmac_f32 v183, v123, v128
    v_mul_f32 v176, v176, v130
    v_mul_f32 v177, v177, v130
    v_mul_f32 v178, v178, v130
    v_mul_f32 v179, v179, v130
    v_mul_f32 v180, v180, v130
    v_mul_f32 v181, v181, v130
    v_mul_f32 v182, v182, v130
    v_mul_f32 v183, v183, v130
    ds_read_b128 v[128:131], v165 offset:768
    v_cvt_pk_bf16_f32 v136, v176, v177
    v_cvt_pk_bf16_f32 v137, v178, v179
    ds_write_b64 v164, v[136:137] offset:8448
    v_cvt_pk_bf16_f32 v138, v180, v181
    v_cvt_pk_bf16_f32 v139, v182, v183
    ds_write_b64 v164, v[138:139] offset:8704
    s_add_u32 s64, s0, 40960
    buffer_load_dwordx4 v[88:91], v253, s[36:39], s64 offen offset:2048 sc1
    s_waitcnt lgkmcnt(5)
    v_fmac_f32 v184, v116, v125
    v_fmac_f32 v185, v117, v124
    v_fmac_f32 v186, v118, v125
    v_fmac_f32 v187, v119, v124
    v_fmac_f32 v188, v120, v125
    v_fmac_f32 v189, v121, v124
    v_fmac_f32 v190, v122, v125
    v_fmac_f32 v191, v123, v124
    v_mul_f32 v184, v184, v126
    v_mul_f32 v185, v185, v126
    v_mul_f32 v186, v186, v126
    v_mul_f32 v187, v187, v126
    v_mul_f32 v188, v188, v126
    v_mul_f32 v189, v189, v126
    v_mul_f32 v190, v190, v126
    v_mul_f32 v191, v191, v126
    ds_read_b128 v[124:127], v165 offset:1024
    v_cvt_pk_bf16_f32 v132, v184, v185
    v_cvt_pk_bf16_f32 v133, v186, v187
    ds_write_b64 v164, v[132:133] offset:16896
    v_cvt_pk_bf16_f32 v134, v188, v189
    v_cvt_pk_bf16_f32 v135, v190, v191
    ds_write_b64 v164, v[134:135] offset:17152
    s_add_u32 s64, s0, 40960
    buffer_load_dwordx4 v[92:95], v253, s[36:39], s64 offen offset:3072 sc1
    s_waitcnt lgkmcnt(5)
    v_fmac_f32 v192, v116, v129
    v_fmac_f32 v193, v117, v128
    v_fmac_f32 v194, v118, v129
    v_fmac_f32 v195, v119, v128
    v_fmac_f32 v196, v120, v129
    v_fmac_f32 v197, v121, v128
    v_fmac_f32 v198, v122, v129
    v_fmac_f32 v199, v123, v128
    v_mul_f32 v192, v192, v130
    v_mul_f32 v193, v193, v130
    v_mul_f32 v194, v194, v130
    v_mul_f32 v195, v195, v130
    v_mul_f32 v196, v196, v130
    v_mul_f32 v197, v197, v130
    v_mul_f32 v198, v198, v130
    v_mul_f32 v199, v199, v130
    ds_read_b128 v[128:131], v165 offset:1280
    v_cvt_pk_bf16_f32 v136, v192, v193
    v_cvt_pk_bf16_f32 v137, v194, v195
    ds_write_b64 v164, v[136:137] offset:25344
    v_cvt_pk_bf16_f32 v138, v196, v197
    v_cvt_pk_bf16_f32 v139, v198, v199
    ds_write_b64 v164, v[138:139] offset:25600
    s_add_u32 s64, s0, 45056
    buffer_load_dwordx4 v[96:99], v253, s[36:39], s64 offen offset:0 sc1
    s_waitcnt lgkmcnt(5)
    v_fmac_f32 v200, v116, v125
    v_fmac_f32 v201, v117, v124
    v_fmac_f32 v202, v118, v125
    v_fmac_f32 v203, v119, v124
    v_fmac_f32 v204, v120, v125
    v_fmac_f32 v205, v121, v124
    v_fmac_f32 v206, v122, v125
    v_fmac_f32 v207, v123, v124
    v_mul_f32 v200, v200, v126
    v_mul_f32 v201, v201, v126
    v_mul_f32 v202, v202, v126
    v_mul_f32 v203, v203, v126
    v_mul_f32 v204, v204, v126
    v_mul_f32 v205, v205, v126
    v_mul_f32 v206, v206, v126
    v_mul_f32 v207, v207, v126
    ds_read_b128 v[124:127], v165 offset:1536
    v_cvt_pk_bf16_f32 v132, v200, v201
    v_cvt_pk_bf16_f32 v133, v202, v203
    ds_write_b64 v164, v[132:133] offset:33792
    v_cvt_pk_bf16_f32 v134, v204, v205
    v_cvt_pk_bf16_f32 v135, v206, v207
    ds_write_b64 v164, v[134:135] offset:34048
    s_add_u32 s64, s0, 81920
    buffer_load_dwordx4 v[100:103], v253, s[36:39], s64 offen offset:0 sc1
    s_waitcnt lgkmcnt(5)
    v_fmac_f32 v208, v116, v129
    v_fmac_f32 v209, v117, v128
    v_fmac_f32 v210, v118, v129
    v_fmac_f32 v211, v119, v128
    v_fmac_f32 v212, v120, v129
    v_fmac_f32 v213, v121, v128
    v_fmac_f32 v214, v122, v129
    v_fmac_f32 v215, v123, v128
    v_mul_f32 v208, v208, v130
    v_mul_f32 v209, v209, v130
    v_mul_f32 v210, v210, v130
    v_mul_f32 v211, v211, v130
    v_mul_f32 v212, v212, v130
    v_mul_f32 v213, v213, v130
    v_mul_f32 v214, v214, v130
    v_mul_f32 v215, v215, v130
    ds_read_b128 v[128:131], v165 offset:1792
    v_cvt_pk_bf16_f32 v136, v208, v209
    v_cvt_pk_bf16_f32 v137, v210, v211
    ds_write_b64 v164, v[136:137] offset:42240
    v_cvt_pk_bf16_f32 v138, v212, v213
    v_cvt_pk_bf16_f32 v139, v214, v215
    ds_write_b64 v164, v[138:139] offset:42496
    s_add_u32 s64, s0, 81920
    buffer_load_dwordx4 v[104:107], v253, s[36:39], s64 offen offset:1024 sc1
    s_waitcnt lgkmcnt(5)
    v_fmac_f32 v216, v116, v125
    v_fmac_f32 v217, v117, v124
    v_fmac_f32 v218, v118, v125
    v_fmac_f32 v219, v119, v124
    v_fmac_f32 v220, v120, v125
    v_fmac_f32 v221, v121, v124
    v_fmac_f32 v222, v122, v125
    v_fmac_f32 v223, v123, v124
    v_mul_f32 v216, v216, v126
    v_mul_f32 v217, v217, v126
    v_mul_f32 v218, v218, v126
    v_mul_f32 v219, v219, v126
    v_mul_f32 v220, v220, v126
    v_mul_f32 v221, v221, v126
    v_mul_f32 v222, v222, v126
    v_mul_f32 v223, v223, v126
    ds_read_b128 v[124:127], v165 offset:2048
    v_cvt_pk_bf16_f32 v132, v216, v217
    v_cvt_pk_bf16_f32 v133, v218, v219
    ds_write_b64 v164, v[132:133] offset:50688
    v_cvt_pk_bf16_f32 v134, v220, v221
    v_cvt_pk_bf16_f32 v135, v222, v223
    ds_write_b64 v164, v[134:135] offset:50944
    s_add_u32 s64, s0, 81920
    buffer_load_dwordx4 v[108:111], v253, s[36:39], s64 offen offset:2048 sc1
    s_waitcnt lgkmcnt(5)
    v_fmac_f32 v224, v116, v129
    v_fmac_f32 v225, v117, v128
    v_fmac_f32 v226, v118, v129
    v_fmac_f32 v227, v119, v128
    v_fmac_f32 v228, v120, v129
    v_fmac_f32 v229, v121, v128
    v_fmac_f32 v230, v122, v129
    v_fmac_f32 v231, v123, v128
    v_mul_f32 v224, v224, v130
    v_mul_f32 v225, v225, v130
    v_mul_f32 v226, v226, v130
    v_mul_f32 v227, v227, v130
    v_mul_f32 v228, v228, v130
    v_mul_f32 v229, v229, v130
    v_mul_f32 v230, v230, v130
    v_mul_f32 v231, v231, v130
    ds_read_b128 v[128:131], v165 offset:2304
    v_cvt_pk_bf16_f32 v136, v224, v225
    v_cvt_pk_bf16_f32 v137, v226, v227
    ds_write_b64 v248, v[136:137] offset:0
    v_cvt_pk_bf16_f32 v138, v228, v229
    v_cvt_pk_bf16_f32 v139, v230, v231
    ds_write_b64 v248, v[138:139] offset:256
    s_add_u32 s64, s0, 81920
    buffer_load_dwordx4 v[112:115], v253, s[36:39], s64 offen offset:3072 sc1
    s_waitcnt lgkmcnt(5)
    v_fmac_f32 v232, v116, v125
    v_fmac_f32 v233, v117, v124
    v_fmac_f32 v234, v118, v125
    v_fmac_f32 v235, v119, v124
    v_fmac_f32 v236, v120, v125
    v_fmac_f32 v237, v121, v124
    v_fmac_f32 v238, v122, v125
    v_fmac_f32 v239, v123, v124
    v_mul_f32 v232, v232, v126
    v_mul_f32 v233, v233, v126
    v_mul_f32 v234, v234, v126
    v_mul_f32 v235, v235, v126
    v_mul_f32 v236, v236, v126
    v_mul_f32 v237, v237, v126
    v_mul_f32 v238, v238, v126
    v_mul_f32 v239, v239, v126
    v_cvt_pk_bf16_f32 v132, v232, v233
    v_cvt_pk_bf16_f32 v133, v234, v235
    ds_write_b64 v248, v[132:133] offset:8448
    v_cvt_pk_bf16_f32 v134, v236, v237
    v_cvt_pk_bf16_f32 v135, v238, v239
    ds_write_b64 v248, v[134:135] offset:8704
    s_waitcnt lgkmcnt(4)
    v_fmac_f32 v240, v116, v129
    v_fmac_f32 v241, v117, v128
    v_fmac_f32 v242, v118, v129
    v_fmac_f32 v243, v119, v128
    v_fmac_f32 v244, v120, v129
    v_fmac_f32 v245, v121, v128
    v_fmac_f32 v246, v122, v129
    v_fmac_f32 v247, v123, v128
    v_mul_f32 v240, v240, v130
    v_mul_f32 v241, v241, v130
    v_mul_f32 v242, v242, v130
    v_mul_f32 v243, v243, v130
    v_mul_f32 v244, v244, v130
    v_mul_f32 v245, v245, v130
    v_mul_f32 v246, v246, v130
    v_mul_f32 v247, v247, v130
    v_cvt_pk_bf16_f32 v136, v240, v241
    v_cvt_pk_bf16_f32 v137, v242, v243
    ds_write_b64 v248, v[136:137] offset:16896
    v_cvt_pk_bf16_f32 v138, v244, v245
    v_cvt_pk_bf16_f32 v139, v246, v247
    ds_write_b64 v248, v[138:139] offset:17152
    v_mov_b32 v246, s68
    v_cmp_gt_u32 vcc, 32, v254
    v_min_f32 v232, s67, v144
    v_min_f32 v233, s67, v145
    v_min_f32 v234, s67, v146
    v_min_f32 v235, s67, v147
    v_cndmask_b32 v246, 0, v246, vcc
    v_min_f32 v228, v246, v140
    v_min_f32 v229, v246, v141
    v_min_f32 v230, v246, v142
    v_min_f32 v231, v246, v143
    v_mov_b32 v248, 1065369472
    v_mov_b32 v249, 1065369472
    v_mov_b32 v250, 1065369472
    v_mov_b32 v251, 1065369472
    s_waitcnt lgkmcnt(0)
    s_barrier
    ds_read_b64 v[164:165], v150 offset:8448
    ds_read_b64 v[166:167], v151 offset:8448
    ds_read_b64 v[168:169], v150 offset:8608
    ds_read_b64 v[170:171], v153 offset:8640
    ds_read_b64 v[172:173], v150 offset:160
    ds_read_b64 v[174:175], v153 offset:192
    ds_read_b64 v[176:177], v150 offset:8488
    ds_read_b64 v[178:179], v152 offset:8448
    ds_read_b64 v[180:181], v150 offset:8648
    ds_read_b64 v[182:183], v153 offset:8680
    ds_read_b64 v[184:185], v150 offset:200
    ds_read_b64 v[186:187], v153 offset:232
    ds_read_b64_tr_b16 v[188:189], v154 offset:320
    ds_read_b64_tr_b16 v[192:193], v155 offset:352
    ds_read_b64_tr_b16 v[190:191], v154 offset:8768
    ds_read_b64_tr_b16 v[194:195], v155 offset:8800
    ds_read_b64_tr_b16 v[196:197], v154 offset:360
    ds_read_b64_tr_b16 v[200:201], v155 offset:392
    ds_read_b64_tr_b16 v[198:199], v154 offset:8808
    ds_read_b64_tr_b16 v[202:203], v155 offset:8840
    s_waitcnt lgkmcnt(15)
    v_mfma_f32_16x16x32_bf16 v[204:207], v[168:171], v[164:167], v[228:231]
    s_waitcnt lgkmcnt(14)
    v_mfma_f32_16x16x32_bf16 v[208:211], v[172:175], v[164:167], v[232:235]
    s_waitcnt lgkmcnt(10)
    v_mfma_f32_16x16x32_bf16 v[212:215], v[180:183], v[176:179], v[228:231]
    s_waitcnt lgkmcnt(8)
    v_mfma_f32_16x16x32_bf16 v[216:219], v[184:187], v[176:179], v[232:235]
    ds_read_b64 v[164:165], v150 offset:16896
    ds_read_b64 v[166:167], v151 offset:16896
    ds_read_b64 v[172:173], v150 offset:17056
    ds_read_b64 v[174:175], v153 offset:17088
    ds_read_b64 v[176:177], v150 offset:16936
    ds_read_b64 v[178:179], v152 offset:16896
    ds_read_b64 v[184:185], v150 offset:17096
    ds_read_b64 v[186:187], v153 offset:17128
    v_max_f32 v204, v204, v208
    v_max_f32 v205, v205, v209
    v_max_f32 v206, v206, v210
    v_max_f32 v207, v207, v211
    v_max_f32 v212, v212, v216
    v_max_f32 v213, v213, v217
    v_max_f32 v214, v214, v218
    v_max_f32 v215, v215, v219
    v_max3_f32 v244, v204, v205, v206
    v_max3_f32 v245, v212, v213, v214
    v_max_f32 v244, v244, v207
    v_max_f32 v245, v245, v215
    s_add_u32 s64, s0, 86016
    buffer_load_dwordx4 v[116:119], v253, s[36:39], s64 offen offset:0 sc1
    v_permlane32_swap_b32 v244, v245
    v_max_f32 v246, v244, v245
    v_max_f32 v247, v244, v245
    s_add_u32 s64, s0, 122880
    buffer_load_dwordx4 v[120:123], v253, s[36:39], s64 offen offset:0 sc1
    v_permlane16_swap_b32 v246, v247
    v_max_f32 v246, v246, v247
    v_mul_f32 v244, v246, v159
    v_mul_f32 v245, v246, v159
    s_nop 1
    v_permlane32_swap_b32 v244, v245
    v_fma_f32 v204, v204, v159, -v244
    v_fma_f32 v205, v205, v159, -v244
    v_fma_f32 v206, v206, v159, -v244
    v_fma_f32 v207, v207, v159, -v244
    v_fma_f32 v212, v212, v159, -v245
    v_fma_f32 v213, v213, v159, -v245
    v_fma_f32 v214, v214, v159, -v245
    v_fma_f32 v215, v215, v159, -v245
    v_exp_f32 v204, v204
    v_exp_f32 v205, v205
    v_exp_f32 v206, v206
    v_exp_f32 v207, v207
    v_exp_f32 v212, v212
    v_exp_f32 v213, v213
    v_exp_f32 v214, v214
    v_exp_f32 v215, v215
    s_cmp_ge_u32 s48, 4
    s_cbranch_scc1 .L7_para
    s_add_u32 s64, s0, 163840
    s_add_u32 m0, s71, 0
    s_nop 0
    buffer_load_dwordx4 v253, s[36:39], s64 offen sc1 lds
    s_add_u32 s64, s0, 164864
    s_add_u32 m0, s71, 1024
    s_nop 0
    buffer_load_dwordx4 v253, s[36:39], s64 offen sc1 lds
.L7_para:
    v_cvt_pk_bf16_f32 v208, v204, v205
    v_cvt_pk_bf16_f32 v209, v206, v207
    v_cvt_pk_bf16_f32 v216, v212, v213
    v_cvt_pk_bf16_f32 v217, v214, v215
    v_and_b32 v220, v148, v208
    v_and_b32 v221, v149, v209
    v_xor_b32 v222, v220, v208
    v_xor_b32 v223, v221, v209
    v_and_b32 v224, v148, v216
    v_and_b32 v225, v149, v217
    v_xor_b32 v226, v224, v216
    v_xor_b32 v227, v225, v217
    v_mfma_f32_16x16x32_bf16 v[244:247], v[248:251], v[220:223], 0
    s_nop 0
    v_mfma_f32_16x16x32_bf16 v[160:163], v[248:251], v[224:227], 0
    s_waitcnt lgkmcnt(12)
    v_mfma_f32_16x16x32_bf16 v[228:231], v[188:191], v[220:223], 0
    v_mfma_f32_16x16x32_bf16 v[232:235], v[192:195], v[220:223], 0
    s_waitcnt lgkmcnt(8)
    v_mfma_f32_16x16x32_bf16 v[236:239], v[196:199], v[224:227], 0
    v_mfma_f32_16x16x32_bf16 v[240:243], v[200:203], v[224:227], 0
    s_waitcnt lgkmcnt(4)
    v_mfma_f32_16x16x32_bf16 v[204:207], v[172:175], v[164:167], v[140:143]
    v_mfma_f32_16x16x32_bf16 v[208:211], v[168:171], v[164:167], v[144:147]
    s_waitcnt lgkmcnt(0)
    v_mfma_f32_16x16x32_bf16 v[212:215], v[184:187], v[176:179], v[140:143]
    v_mfma_f32_16x16x32_bf16 v[216:219], v[180:183], v[176:179], v[144:147]
    ds_read_b64_tr_b16 v[188:189], v154 offset:17216
    ds_read_b64_tr_b16 v[192:193], v155 offset:17248
    ds_read_b64_tr_b16 v[196:197], v154 offset:17256
    ds_read_b64_tr_b16 v[200:201], v155 offset:17288
    s_add_u32 s64, s0, 122880
    buffer_load_dwordx4 v[124:127], v253, s[36:39], s64 offen offset:1024 sc1
    s_cmp_lg_u32 s48, 0
    s_cbranch_scc1 .L9_para
    buffer_load_dwordx4 v[136:139], v252, s[36:39], 0 offen sc1
.L9_para:
    v_rcp_f32 v244, v244
    v_rcp_f32 v160, v160
    v_mul_f32 v228, v228, v244
    v_mul_f32 v229, v229, v244
    v_mul_f32 v230, v230, v244
    v_mul_f32 v231, v231, v244
    v_mul_f32 v232, v232, v244
    v_mul_f32 v233, v233, v244
    v_mul_f32 v234, v234, v244
    v_mul_f32 v235, v235, v244
    v_mul_f32 v236, v236, v160
    v_mul_f32 v237, v237, v160
    v_mul_f32 v238, v238, v160
    v_mul_f32 v239, v239, v160
    v_mul_f32 v240, v240, v160
    v_mul_f32 v241, v241, v160
    v_mul_f32 v242, v242, v160
    v_mul_f32 v243, v243, v160
    v_cvt_pk_bf16_f32 v220, v228, v229
    v_cvt_pk_bf16_f32 v221, v230, v231
    v_cvt_pk_bf16_f32 v222, v236, v237
    v_cvt_pk_bf16_f32 v223, v238, v239
    buffer_store_dwordx4 v[220:223], v156, s[36:39], s70 offen sc1
    v_cvt_pk_bf16_f32 v224, v232, v233
    v_cvt_pk_bf16_f32 v225, v234, v235
    v_cvt_pk_bf16_f32 v226, v240, v241
    v_cvt_pk_bf16_f32 v227, v242, v243
    s_mov_b64 exec, 0xffff
    buffer_store_dwordx4 v[224:227], v156, s[36:39], s73 offen sc1
    s_mov_b64 exec, -1
    s_cmp_ge_u32 s48, 4
    s_cbranch_scc1 .L10_para
    ds_read_b64 v[164:165], v150 offset:25344
    ds_read_b64 v[166:167], v151 offset:25344
    ds_read_b64 v[168:169], v150 offset:25504
    ds_read_b64 v[170:171], v153 offset:25536
    ds_read_b64 v[176:177], v150 offset:25384
    ds_read_b64 v[178:179], v152 offset:25344
    ds_read_b64 v[180:181], v150 offset:25544
    ds_read_b64 v[182:183], v153 offset:25576
.L10_para:
    v_max_f32 v204, v204, v208
    v_max_f32 v205, v205, v209
    v_max_f32 v206, v206, v210
    v_max_f32 v207, v207, v211
    v_max_f32 v212, v212, v216
    v_max_f32 v213, v213, v217
    v_max_f32 v214, v214, v218
    v_max_f32 v215, v215, v219
    v_max3_f32 v244, v204, v205, v206
    v_max3_f32 v245, v212, v213, v214
    v_max_f32 v244, v244, v207
    v_max_f32 v245, v245, v215
    s_add_u32 s64, s0, 122880
    buffer_load_dwordx4 v[128:131], v253, s[36:39], s64 offen offset:2048 sc1
    v_permlane32_swap_b32 v244, v245
    v_max_f32 v246, v244, v245
    v_max_f32 v247, v244, v245
    s_nop 1
    v_permlane16_swap_b32 v246, v247
    v_max_f32 v246, v246, v247
    v_mul_f32 v244, v246, v159
    v_mul_f32 v245, v246, v159
    s_cmp_ge_u32 s48, 4
    s_cbranch_scc1 .L8_para
    s_add_u32 s64, s0, 165888
    s_add_u32 m0, s71, 2048
    s_nop 0
    buffer_load_dwordx4 v253, s[36:39], s64 offen sc1 lds
    s_add_u32 s64, s0, 166912
    s_add_u32 m0, s71, 3072
    s_nop 0
    buffer_load_dwordx4 v253, s[36:39], s64 offen sc1 lds
.L8_para:
    v_permlane32_swap_b32 v244, v245
    v_fma_f32 v204, v204, v159, -v244
    v_fma_f32 v205, v205, v159, -v244
    v_fma_f32 v206, v206, v159, -v244
    v_fma_f32 v207, v207, v159, -v244
    v_fma_f32 v212, v212, v159, -v245
    v_fma_f32 v213, v213, v159, -v245
    v_fma_f32 v214, v214, v159, -v245
    v_fma_f32 v215, v215, v159, -v245
    v_exp_f32 v204, v204
    v_exp_f32 v205, v205
    v_exp_f32 v206, v206
    v_exp_f32 v207, v207
    v_exp_f32 v212, v212
    v_exp_f32 v213, v213
    v_exp_f32 v214, v214
    v_exp_f32 v215, v215
    s_add_u32 s64, s0, 122880
    buffer_load_dwordx4 v[132:135], v253, s[36:39], s64 offen offset:3072 sc1
    v_cvt_pk_bf16_f32 v208, v204, v205
    v_cvt_pk_bf16_f32 v209, v206, v207
    v_cvt_pk_bf16_f32 v216, v212, v213
    v_cvt_pk_bf16_f32 v217, v214, v215
    v_and_b32 v222, v148, v208
    v_and_b32 v223, v149, v209
    v_xor_b32 v220, v222, v208
    v_xor_b32 v221, v223, v209
    v_and_b32 v226, v148, v216
    v_and_b32 v227, v149, v217
    v_xor_b32 v224, v226, v216
    v_xor_b32 v225, v227, v217
    v_mfma_f32_16x16x32_bf16 v[244:247], v[248:251], v[220:223], 0
    s_nop 0
    v_mfma_f32_16x16x32_bf16 v[160:163], v[248:251], v[224:227], 0
    s_waitcnt lgkmcnt(2)
    v_mfma_f32_16x16x32_bf16 v[228:231], v[188:191], v[220:223], 0
    v_mfma_f32_16x16x32_bf16 v[232:235], v[192:195], v[220:223], 0
    s_waitcnt lgkmcnt(0)
    v_mfma_f32_16x16x32_bf16 v[236:239], v[196:199], v[224:227], 0
    v_mfma_f32_16x16x32_bf16 v[240:243], v[200:203], v[224:227], 0
    s_cmp_ge_u32 s48, 4
    s_cbranch_scc1 .L11_para
    s_waitcnt lgkmcnt(4)
    v_mfma_f32_16x16x32_bf16 v[204:207], v[168:171], v[164:167], v[140:143]
    v_mfma_f32_16x16x32_bf16 v[208:211], v[172:175], v[164:167], v[144:147]
    s_waitcnt lgkmcnt(0)
    v_mfma_f32_16x16x32_bf16 v[212:215], v[180:183], v[176:179], v[140:143]
    v_mfma_f32_16x16x32_bf16 v[216:219], v[184:187], v[176:179], v[144:147]
    ds_read_b64_tr_b16 v[190:191], v154 offset:25664
    ds_read_b64_tr_b16 v[194:195], v155 offset:25696
    ds_read_b64_tr_b16 v[198:199], v154 offset:25704
    ds_read_b64_tr_b16 v[202:203], v155 offset:25736
    s_cmp_lg_u32 s48, 0
    s_cbranch_scc1 .L12_para
    s_waitcnt vmcnt(6)
    v_xor_b32 v136, s20, v136
    v_xor_b32 v137, s20, v137
    v_xor_b32 v138, s20, v138
    v_xor_b32 v139, s20, v139
    v_or_b32 v136, v136, v137
    v_or3_b32 v136, v136, v138, v139
    v_cmp_ne_u32 vcc, 0, v136
    v_mov_b32 v138, 163776
    s_cmp_eq_u32 vcc_lo, 0
    s_cselect_b32 s56, 1, 0
    s_cmp_eq_u32 vcc_hi, 0
    s_cselect_b32 s57, 1, 0
    v_mov_b32 v136, s56
    v_mov_b32 v137, s57
    s_mov_b64 exec, 1
    ds_or_b32 v138, v136 offset:20
    ds_or_b32 v138, v137 offset:8
    s_mov_b64 exec, -1
.L12_para:
    s_add_u32 s64, s0, 126976
    buffer_load_dwordx4 v[136:139], v253, s[36:39], s64 offen offset:0 sc1
    s_add_u32 s64, s0, 167936
    s_add_u32 m0, s71, 4096
    s_nop 0
    buffer_load_dwordx4 v253, s[36:39], s64 offen sc1 lds
    v_rcp_f32 v244, v244
    v_rcp_f32 v160, v160
    v_mul_f32 v228, v228, v244
    v_mul_f32 v229, v229, v244
    v_mul_f32 v230, v230, v244
    v_mul_f32 v231, v231, v244
    v_mul_f32 v232, v232, v244
    v_mul_f32 v233, v233, v244
    v_mul_f32 v234, v234, v244
    v_mul_f32 v235, v235, v244
    v_mul_f32 v236, v236, v160
    v_mul_f32 v237, v237, v160
    v_mul_f32 v238, v238, v160
    v_mul_f32 v239, v239, v160
    v_mul_f32 v240, v240, v160
    v_mul_f32 v241, v241, v160
    v_mul_f32 v242, v242, v160
    v_mul_f32 v243, v243, v160
    v_cvt_pk_bf16_f32 v220, v228, v229
    v_cvt_pk_bf16_f32 v221, v230, v231
    v_cvt_pk_bf16_f32 v222, v236, v237
    v_cvt_pk_bf16_f32 v223, v238, v239
    buffer_store_dwordx4 v[220:223], v157, s[36:39], s70 offen sc1
    v_cvt_pk_bf16_f32 v224, v232, v233
    v_cvt_pk_bf16_f32 v225, v234, v235
    v_cvt_pk_bf16_f32 v226, v240, v241
    v_cvt_pk_bf16_f32 v227, v242, v243
    s_mov_b64 exec, 0xffff
    buffer_store_dwordx4 v[224:227], v157, s[36:39], s73 offen sc1
    s_mov_b64 exec, -1
    v_max_f32 v204, v204, v208
    v_max_f32 v205, v205, v209
    v_max_f32 v206, v206, v210
    v_max_f32 v207, v207, v211
    v_max_f32 v212, v212, v216
    v_max_f32 v213, v213, v217
    v_max_f32 v214, v214, v218
    v_max_f32 v215, v215, v219
    v_max3_f32 v244, v204, v205, v206
    v_max3_f32 v245, v212, v213, v214
    v_max_f32 v244, v244, v207
    v_max_f32 v245, v245, v215
    s_add_u32 s64, s0, 204800
    s_add_u32 m0, s72, 0
    s_nop 0
    buffer_load_dwordx4 v253, s[36:39], s64 offen sc1 lds
    v_permlane32_swap_b32 v244, v245
    v_max_f32 v246, v244, v245
    v_max_f32 v247, v244, v245
    s_add_u32 s64, s0, 205824
    s_add_u32 m0, s72, 1024
    s_nop 0
    buffer_load_dwordx4 v253, s[36:39], s64 offen sc1 lds
    v_permlane16_swap_b32 v246, v247
    v_max_f32 v246, v246, v247
    v_mul_f32 v244, v246, v159
    v_mul_f32 v245, v246, v159
    s_add_u32 s64, s0, 206848
    s_add_u32 m0, s72, 2048
    s_nop 0
    buffer_load_dwordx4 v253, s[36:39], s64 offen sc1 lds
    v_permlane32_swap_b32 v244, v245
    v_fma_f32 v204, v204, v159, -v244
    v_fma_f32 v205, v205, v159, -v244
    v_fma_f32 v206, v206, v159, -v244
    v_fma_f32 v207, v207, v159, -v244
    v_fma_f32 v212, v212, v159, -v245
    v_fma_f32 v213, v213, v159, -v245
    v_fma_f32 v214, v214, v159, -v245
    v_fma_f32 v215, v215, v159, -v245
    v_exp_f32 v204, v204
    v_exp_f32 v205, v205
    v_exp_f32 v206, v206
    v_exp_f32 v207, v207
    v_exp_f32 v212, v212
    v_exp_f32 v213, v213
    v_exp_f32 v214, v214
    v_exp_f32 v215, v215
    s_add_u32 s64, s0, 207872
    s_add_u32 m0, s72, 3072
    s_nop 0
    buffer_load_dwordx4 v253, s[36:39], s64 offen sc1 lds
    v_cvt_pk_bf16_f32 v208, v204, v205
    v_cvt_pk_bf16_f32 v209, v206, v207
    v_cvt_pk_bf16_f32 v216, v212, v213
    v_cvt_pk_bf16_f32 v217, v214, v215
    v_and_b32 v220, v148, v208
    v_and_b32 v221, v149, v209
    v_xor_b32 v222, v220, v208
    v_xor_b32 v223, v221, v209
    v_and_b32 v224, v148, v216
    v_and_b32 v225, v149, v217
    v_xor_b32 v226, v224, v216
    v_xor_b32 v227, v225, v217
    v_mfma_f32_16x16x32_bf16 v[244:247], v[248:251], v[220:223], 0
    s_nop 0
    v_mfma_f32_16x16x32_bf16 v[160:163], v[248:251], v[224:227], 0
    s_waitcnt lgkmcnt(2)
    v_mfma_f32_16x16x32_bf16 v[228:231], v[188:191], v[220:223], 0
    v_mfma_f32_16x16x32_bf16 v[232:235], v[192:195], v[220:223], 0
    s_waitcnt lgkmcnt(0)
    v_mfma_f32_16x16x32_bf16 v[236:239], v[196:199], v[224:227], 0
    v_mfma_f32_16x16x32_bf16 v[240:243], v[200:203], v[224:227], 0
    s_add_u32 s64, s0, 208896
    s_add_u32 m0, s72, 4096
    s_nop 0
    buffer_load_dwordx4 v253, s[36:39], s64 offen sc1 lds
    v_rcp_f32 v244, v244
    v_rcp_f32 v160, v160
    v_mul_f32 v228, v228, v244
    v_mul_f32 v229, v229, v244
    v_mul_f32 v230, v230, v244
    v_mul_f32 v231, v231, v244
    v_mul_f32 v232, v232, v244
    v_mul_f32 v233, v233, v244
    v_mul_f32 v234, v234, v244
    v_mul_f32 v235, v235, v244
    v_mul_f32 v236, v236, v160
    v_mul_f32 v237, v237, v160
    v_mul_f32 v238, v238, v160
    v_mul_f32 v239, v239, v160
    v_mul_f32 v240, v240, v160
    v_mul_f32 v241, v241, v160
    v_mul_f32 v242, v242, v160
    v_mul_f32 v243, v243, v160
    v_cvt_pk_bf16_f32 v220, v228, v229
    v_cvt_pk_bf16_f32 v221, v230, v231
    v_cvt_pk_bf16_f32 v222, v236, v237
    v_cvt_pk_bf16_f32 v223, v238, v239
    buffer_store_dwordx4 v[220:223], v158, s[36:39], s70 offen sc1
    v_cvt_pk_bf16_f32 v224, v232, v233
    v_cvt_pk_bf16_f32 v225, v234, v235
    v_cvt_pk_bf16_f32 v226, v240, v241
    v_cvt_pk_bf16_f32 v227, v242, v243
    s_mov_b64 exec, 0xffff
    buffer_store_dwordx4 v[224:227], v158, s[36:39], s73 offen sc1
    s_mov_b64 exec, -1
    v_add_u32 v214, s71, v253
    v_add_u32 v215, s72, v253
    v_mov_b32 v249, v253
    v_mov_b32 v251, 163776
    ds_read_b32 v244, v251 offset:20
    s_waitcnt lgkmcnt(0)
    v_cmp_ne_u32 vcc, 1, v244
    s_cbranch_vccnz .L13_para
    buffer_load_dwordx4 v[220:223], v249, s[36:39], s4 offen offset:0 sc1
    buffer_load_dwordx4 v[224:227], v249, s[36:39], s4 offen offset:1024 sc1
    buffer_load_dwordx4 v[228:231], v249, s[36:39], s4 offen offset:2048 sc1
    buffer_load_dwordx4 v[232:235], v249, s[36:39], s1 offen offset:0 sc1
    buffer_load_dwordx4 v[236:239], v249, s[36:39], s1 offen offset:1024 sc1
    buffer_load_dwordx4 v[240:243], v249, s[36:39], s1 offen offset:2048 sc1
    s_add_u32 s12, s4, 6144
    buffer_load_dwordx4 v[200:203], v249, s[36:39], s12 offen offset:0 sc1
    buffer_load_dwordx4 v[204:207], v249, s[36:39], s12 offen offset:1024 sc1
    buffer_load_dwordx4 v[208:211], v249, s[36:39], s12 offen offset:2048 sc1
    s_waitcnt vmcnt(11)
    ds_read_b128 v[140:143], v214 offset:0
    ds_read_b128 v[144:147], v214 offset:1024
    ds_read_b128 v[148:151], v214 offset:2048
    ds_read_b128 v[152:155], v214 offset:3072
    ds_read_b128 v[156:159], v214 offset:4096
    ds_read_b128 v[160:163], v215 offset:0
    ds_read_b128 v[164:167], v215 offset:1024
    ds_read_b128 v[168:171], v215 offset:2048
    ds_read_b128 v[172:175], v215 offset:3072
    ds_read_b128 v[176:179], v215 offset:4096
    v_mov_b32 v253, 1
    s_mov_b64 exec, 1
    ds_add_u32 v251, v253 offset:28
    s_mov_b64 exec, -1
    v_mul_u32_u24 v218, 4352, v254
    s_mul_i32 s71, s49, 69632
    s_add_u32 s71, s71, 12648448
    s_mov_b32 s61, 0
    s_mov_b32 s60, 4099
    s_cmp_eq_u32 s53, 1
    s_cselect_b32 s60, 4110, s60
    s_cmp_eq_u32 s53, 2
    s_cselect_b32 s60, 8248, s60
    s_cmp_eq_u32 s53, 3
    s_cselect_b32 s60, 8416, s60
    s_cmp_eq_u32 s53, 4
    s_cselect_b32 s60, 17280, s60
    s_cmp_eq_u32 s53, 5
    s_cselect_b32 s60, 20224, s60
    s_cmp_eq_u32 s53, 6
    s_cselect_b32 s60, 35840, s60
    s_lshl_b32 s69, s53, 8
    s_lshl_b32 s56, s52, 2
    s_add_u32 s69, s69, s56
    s_add_u32 s69, s69, s71
    s_cmp_ge_u32 s3, 12
    s_cselect_b32 s65, 1, 0
    s_mul_i32 s52, s3, 4352
    s_add_u32 s52, s52, s71
    s_lshl_b32 s14, s14, 8
    s_add_u32 s14, s14, s52
    s_lshl_b32 s21, s21, 8
    s_add_u32 s21, s21, s52
    s_mov_b32 s22, s20
    s_mov_b32 s23, s20
    v_and_b32 v216, 15, v254
    v_lshrrev_b32 v217, 4, v254
    v_mul_u32_u24 v250, 336, v216
    v_lshl_add_u32 v250, v217, 4, v250
    s_and_b32 s68, s48, 3
    s_mul_i32 s56, s68, 21504
    v_add_u32 v250, s56, v250
    s_lshl_b32 s68, s68, 2
    s_add_u32 s56, s68, 163776
    v_mov_b32 v252, s56
    v_mov_b32 v253, 1
    v_mov_b32 v216, s20
    s_mov_b32 s28, s18
    s_and_b32 s29, s19, 0xffff
    s_mov_b32 s30, 2621440
    s_mov_b32 s31, 0x20000
    s_waitcnt vmcnt(9)
    s_mov_b64 exec, 1
    ds_add_rtn_u32 v217, v251, v253
    s_mov_b64 exec, -1
    s_waitcnt lgkmcnt(0)
    v_readfirstlane_b32 s56, v217
    s_nop 0
    s_cmp_lg_u32 s56, 7
    s_cbranch_scc1 .L14_para
    s_mov_b64 exec, s[60:61]
    buffer_store_dword v216, v218, s[36:39], s69 offen sc1
    s_mov_b64 exec, -1
.L14_para:
    s_branch .Lp2old
.L13_para:
    v_bfe_u32 v216, v254, 2, 3
    v_add_u32 v216, s16, v216
    v_min_u32 v216, s17, v216
    v_and_b32 v217, 3, v254
    v_min_u32 v217, 2, v217
    v_lshlrev_b32 v216, 8, v216
    v_lshl_add_u32 v248, v217, 4, v216
    s_lshl_b32 s15, s49, 13
    s_add_u32 s15, s15, 12599296
    s_cmp_lg_u32 s48, 0
    s_cbranch_scc1 .L15_para
    s_mov_b32 exec_hi, 0
    buffer_load_dwordx4 v[244:247], v248, s[36:39], s15 offen sc1
    s_mov_b32 exec_hi, -1
.L15_para:
    s_waitcnt vmcnt(2)
    ds_read_b128 v[140:143], v214 offset:0
    ds_read_b128 v[144:147], v214 offset:1024
    ds_read_b128 v[148:151], v214 offset:2048
    ds_read_b128 v[152:155], v214 offset:3072
    ds_read_b128 v[156:159], v214 offset:4096
    ds_read_b128 v[160:163], v215 offset:0
    ds_read_b128 v[164:167], v215 offset:1024
    ds_read_b128 v[168:171], v215 offset:2048
    ds_read_b128 v[172:175], v215 offset:3072
    ds_read_b128 v[176:179], v215 offset:4096
    v_mov_b32 v253, 1
    s_mov_b64 exec, 1
    ds_add_u32 v251, v253 offset:28
    s_mov_b64 exec, -1
    v_mul_u32_u24 v218, 4352, v254
    s_mul_i32 s71, s49, 69632
    s_add_u32 s71, s71, 12648448
    s_mov_b32 s61, 0
    s_mov_b32 s60, 4099
    s_cmp_eq_u32 s53, 1
    s_cselect_b32 s60, 4110, s60
    s_cmp_eq_u32 s53, 2
    s_cselect_b32 s60, 8248, s60
    s_cmp_eq_u32 s53, 3
    s_cselect_b32 s60, 8416, s60
    s_cmp_eq_u32 s53, 4
    s_cselect_b32 s60, 17280, s60
    s_cmp_eq_u32 s53, 5
    s_cselect_b32 s60, 20224, s60
    s_cmp_eq_u32 s53, 6
    s_cselect_b32 s60, 35840, s60
    s_lshl_b32 s69, s53, 8
    s_lshl_b32 s56, s52, 2
    s_add_u32 s69, s69, s56
    s_add_u32 s69, s69, s71
    s_cmp_ge_u32 s3, 12
    s_cselect_b32 s65, 1, 0
    s_mul_i32 s52, s3, 4352
    s_add_u32 s52, s52, s71
    s_lshl_b32 s14, s14, 8
    s_add_u32 s14, s14, s52
    s_lshl_b32 s21, s21, 8
    s_add_u32 s21, s21, s52
    s_mov_b32 s22, s20
    s_mov_b32 s23, s20
    v_and_b32 v216, 15, v254
    v_lshrrev_b32 v217, 4, v254
    v_mul_u32_u24 v250, 336, v216
    v_lshl_add_u32 v250, v217, 4, v250
    s_and_b32 s68, s48, 3
    s_mul_i32 s56, s68, 21504
    v_add_u32 v250, s56, v250
    s_lshl_b32 s68, s68, 2
    s_add_u32 s56, s68, 163776
    v_mov_b32 v252, s56
    v_mov_b32 v253, 1
    v_mov_b32 v216, s20
    s_mov_b32 s28, s18
    s_and_b32 s29, s19, 0xffff
    s_mov_b32 s30, 2621440
    s_mov_b32 s31, 0x20000
    s_waitcnt vmcnt(0)
    s_mov_b64 exec, 1
    ds_add_rtn_u32 v217, v251, v253
    s_mov_b64 exec, -1
    s_waitcnt lgkmcnt(0)
    v_readfirstlane_b32 s56, v217
    s_nop 0
    s_cmp_lg_u32 s56, 7
    s_cbranch_scc1 .L16_para
    s_mov_b64 exec, s[60:61]
    buffer_store_dword v216, v218, s[36:39], s69 offen sc1
    s_mov_b64 exec, -1
.L16_para:
    s_branch .Lp2
.L11_para:
    s_nop 4
    s_add_u32 s64, s0, 126976
    buffer_load_dwordx4 v[136:139], v253, s[36:39], s64 offen offset:0 sc1
    v_rcp_f32 v244, v244
    v_rcp_f32 v160, v160
    v_mul_f32 v228, v228, v244
    v_mul_f32 v229, v229, v244
    v_mul_f32 v230, v230, v244
    v_mul_f32 v231, v231, v244
    v_mul_f32 v232, v232, v244
    v_mul_f32 v233, v233, v244
    v_mul_f32 v234, v234, v244
    v_mul_f32 v235, v235, v244
    v_mul_f32 v236, v236, v160
    v_mul_f32 v237, v237, v160
    v_mul_f32 v238, v238, v160
    v_mul_f32 v239, v239, v160
    v_mul_f32 v240, v240, v160
    v_mul_f32 v241, v241, v160
    v_mul_f32 v242, v242, v160
    v_mul_f32 v243, v243, v160
    v_cvt_pk_bf16_f32 v220, v228, v229
    v_cvt_pk_bf16_f32 v221, v230, v231
    v_cvt_pk_bf16_f32 v222, v236, v237
    v_cvt_pk_bf16_f32 v223, v238, v239
    buffer_store_dwordx4 v[220:223], v157, s[36:39], s70 offen sc1
    v_cvt_pk_bf16_f32 v224, v232, v233
    v_cvt_pk_bf16_f32 v225, v234, v235
    v_cvt_pk_bf16_f32 v226, v240, v241
    v_cvt_pk_bf16_f32 v227, v242, v243
    s_mov_b64 exec, 0xffff
    buffer_store_dwordx4 v[224:227], v157, s[36:39], s73 offen sc1
    s_mov_b64 exec, -1
    v_mov_b32 v249, v253
    v_mov_b32 v251, 163776
    ds_read_b32 v244, v251 offset:20
    s_waitcnt lgkmcnt(0)
    v_cmp_ne_u32 vcc, 1, v244
    s_cbranch_vccnz .L17_para
    v_mov_b32 v253, 1
    s_mov_b64 exec, 1
    ds_add_u32 v251, v253 offset:28
    s_mov_b64 exec, -1
    v_mul_u32_u24 v218, 4352, v254
    s_mul_i32 s71, s49, 69632
    s_add_u32 s71, s71, 12648448
    s_mov_b32 s61, 0
    s_mov_b32 s60, 4099
    s_cmp_eq_u32 s53, 1
    s_cselect_b32 s60, 4110, s60
    s_cmp_eq_u32 s53, 2
    s_cselect_b32 s60, 8248, s60
    s_cmp_eq_u32 s53, 3
    s_cselect_b32 s60, 8416, s60
    s_cmp_eq_u32 s53, 4
    s_cselect_b32 s60, 17280, s60
    s_cmp_eq_u32 s53, 5
    s_cselect_b32 s60, 20224, s60
    s_cmp_eq_u32 s53, 6
    s_cselect_b32 s60, 35840, s60
    s_lshl_b32 s69, s53, 8
    s_lshl_b32 s56, s52, 2
    s_add_u32 s69, s69, s56
    s_add_u32 s69, s69, s71
    s_cmp_ge_u32 s3, 12
    s_cselect_b32 s65, 1, 0
    s_mul_i32 s52, s3, 4352
    s_add_u32 s52, s52, s71
    s_lshl_b32 s14, s14, 8
    s_add_u32 s14, s14, s52
    s_lshl_b32 s21, s21, 8
    s_add_u32 s21, s21, s52
    s_mov_b32 s22, s20
    s_mov_b32 s23, s20
    v_and_b32 v216, 15, v254
    v_lshrrev_b32 v217, 4, v254
    v_mul_u32_u24 v250, 336, v216
    v_lshl_add_u32 v250, v217, 4, v250
    s_and_b32 s68, s48, 3
    s_mul_i32 s56, s68, 21504
    v_add_u32 v250, s56, v250
    s_lshl_b32 s68, s68, 2
    s_add_u32 s56, s68, 163776
    v_mov_b32 v252, s56
    v_mov_b32 v253, 1
    v_mov_b32 v216, s20
    s_mov_b32 s28, s18
    s_and_b32 s29, s19, 0xffff
    s_mov_b32 s30, 2621440
    s_mov_b32 s31, 0x20000
    s_waitcnt vmcnt(0)
    s_mov_b64 exec, 1
    ds_add_rtn_u32 v217, v251, v253
    s_mov_b64 exec, -1
    s_waitcnt lgkmcnt(0)
    v_readfirstlane_b32 s56, v217
    s_nop 0
    s_cmp_lg_u32 s56, 7
    s_cbranch_scc1 .L18_para
    s_mov_b64 exec, s[60:61]
    buffer_store_dword v216, v218, s[36:39], s69 offen sc1
    s_mov_b64 exec, -1
.L18_para:
    buffer_load_dwordx4 v[220:223], v249, s[36:39], s4 offen offset:0 sc1
    buffer_load_dwordx4 v[224:227], v249, s[36:39], s4 offen offset:1024 sc1
    buffer_load_dwordx4 v[228:231], v249, s[36:39], s4 offen offset:2048 sc1
    buffer_load_dwordx4 v[232:235], v249, s[36:39], s1 offen offset:0 sc1
    buffer_load_dwordx4 v[236:239], v249, s[36:39], s1 offen offset:1024 sc1
    buffer_load_dwordx4 v[240:243], v249, s[36:39], s1 offen offset:2048 sc1
    s_branch .Lp2y
.L17_para:
    v_mov_b32 v253, 1
    s_mov_b64 exec, 1
    ds_add_u32 v251, v253 offset:28
    s_mov_b64 exec, -1
    v_mul_u32_u24 v218, 4352, v254
    s_mul_i32 s71, s49, 69632
    s_add_u32 s71, s71, 12648448
    s_mov_b32 s61, 0
    s_mov_b32 s60, 4099
    s_cmp_eq_u32 s53, 1
    s_cselect_b32 s60, 4110, s60
    s_cmp_eq_u32 s53, 2
    s_cselect_b32 s60, 8248, s60
    s_cmp_eq_u32 s53, 3
    s_cselect_b32 s60, 8416, s60
    s_cmp_eq_u32 s53, 4
    s_cselect_b32 s60, 17280, s60
    s_cmp_eq_u32 s53, 5
    s_cselect_b32 s60, 20224, s60
    s_cmp_eq_u32 s53, 6
    s_cselect_b32 s60, 35840, s60
    s_lshl_b32 s69, s53, 8
    s_lshl_b32 s56, s52, 2
    s_add_u32 s69, s69, s56
    s_add_u32 s69, s69, s71
    s_cmp_ge_u32 s3, 12
    s_cselect_b32 s65, 1, 0
    s_mul_i32 s52, s3, 4352
    s_add_u32 s52, s52, s71
    s_lshl_b32 s14, s14, 8
    s_add_u32 s14, s14, s52
    s_lshl_b32 s21, s21, 8
    s_add_u32 s21, s21, s52
    s_mov_b32 s22, s20
    s_mov_b32 s23, s20
    v_and_b32 v216, 15, v254
    v_lshrrev_b32 v217, 4, v254
    v_mul_u32_u24 v250, 336, v216
    v_lshl_add_u32 v250, v217, 4, v250
    s_and_b32 s68, s48, 3
    s_mul_i32 s56, s68, 21504
    v_add_u32 v250, s56, v250
    s_lshl_b32 s68, s68, 2
    s_add_u32 s56, s68, 163776
    v_mov_b32 v252, s56
    v_mov_b32 v253, 1
    v_mov_b32 v216, s20
    s_mov_b32 s28, s18
    s_and_b32 s29, s19, 0xffff
    s_mov_b32 s30, 2621440
    s_mov_b32 s31, 0x20000
    s_waitcnt vmcnt(0)
    s_mov_b64 exec, 1
    ds_add_rtn_u32 v217, v251, v253
    s_mov_b64 exec, -1
    s_waitcnt lgkmcnt(0)
    v_readfirstlane_b32 s56, v217
    s_nop 0
    s_cmp_lg_u32 s56, 7
    s_cbranch_scc1 .L19_para
    s_mov_b64 exec, s[60:61]
    buffer_store_dword v216, v218, s[36:39], s69 offen sc1
    s_mov_b64 exec, -1
.L19_para:
    s_branch .Lp2
    .p2align 6
.LtypeB:
    s_sub_u32 s62, s51, 14
    s_mul_i32 s56, s62, 43
    s_lshr_b32 s56, s56, 8
    s_mul_i32 s57, s56, 6
    s_sub_u32 s53, s62, s57
    s_mul_i32 s52, s50, 3
    s_add_u32 s52, s52, s56
    s_lshl_b32 s56, s53, 4
    s_lshl_b32 s57, s49, 3
    s_add_u32 s56, s56, s57
    s_add_u32 s56, s56, s48
    s_add_u32 s56, s56, 0
    s_mul_i32 s56, s56, 3072
    s_lshl_b32 s57, s52, 8
    s_add_u32 s56, s56, s57
    v_lshrrev_b32 v130, 1, v254
    v_mul_u32_u24 v130, 294912, v130
    v_and_b32 v131, 1, v254
    v_lshlrev_b32 v131, 7, v131
    v_add3_u32 v130, v130, v131, s56
    s_waitcnt lgkmcnt(0)
    s_mov_b32 s24, s4
    s_and_b32 s25, s5, 0xffff
    s_mov_b32 s26, 2621440
    s_mov_b32 s27, 0x20000
    s_mov_b32 s28, s12
    s_and_b32 s29, s13, 0xffff
    s_mov_b32 s30, 1966080
    s_mov_b32 s31, 0x20000
    s_mov_b32 s32, s14
    s_and_b32 s33, s15, 0xffff
    s_mov_b32 s34, 1966080
    s_mov_b32 s35, 0x20000
    s_mov_b64 exec, 15
    buffer_load_dword v131, v130, s[28:31], 0 offen
    s_mov_b64 exec, -1
    s_mov_b64 exec, 15
    buffer_load_dword v131, v130, s[32:35], 0 offen
    s_mov_b64 exec, -1
    v_lshrrev_b32 v140, 4, v254
    s_lshl_b32 s56, s48, 1
    s_and_b32 s56, s56, 4
    v_or_b32 v141, s56, v140
    v_bfe_u32 v142, v254, 1, 3
    v_xor_b32 v142, v142, v141
    v_and_b32 v143, 1, v254
    v_lshlrev_b32 v143, 4, v143
    v_lshl_or_b32 v142, v142, 5, v143
    s_mul_i32 s56, s48, 12288
    s_lshl_b32 s57, s52, 8
    s_add_u32 s56, s56, s57
    v_mul_u32_u24 v251, 3072, v140
    v_add3_u32 v251, v251, v142, s56
    s_add_u32 m0, s54, 0
    s_mov_b32 s65, 0
    buffer_load_dwordx4 v251, s[28:31], s65 offen lds
    s_add_u32 m0, s54, 16384
    s_mov_b32 s65, 0
    buffer_load_dwordx4 v251, s[32:35], s65 offen lds
    s_mul_i32 s63, s49, 1280
    s_mul_i32 s66, s53, 160
    s_sub_u32 s66, s66, 16
    s_mul_i32 s67, s53, 11
    s_add_u32 s67, s67, 959
    s_cmp_lt_u32 s48, 2
    s_cselect_b32 s57, s67, s66
    s_cselect_b32 s68, 12, 64
    v_lshrrev_b32 v140, 3, v254
    s_lshl_b32 s56, s48, 3
    v_add_u32 v141, s56, v140
    v_add_u32 v139, s57, v141
    v_bfe_u32 v142, v141, 1, 3
    v_and_b32 v143, 7, v254
    v_xor_b32 v142, v142, v143
    v_lshlrev_b32 v142, 4, v142
    v_mul_u32_u24 v252, 2560, v139
    v_add3_u32 v252, v252, v142, s63
    v_mov_b32 v143, 2130706432
    v_cmp_gt_u32 vcc, s68, v141
    s_nop 1
    v_cndmask_b32 v252, v143, v252, vcc
    v_cmp_gt_u32 vcc, 1024, v139
    s_nop 1
    v_cndmask_b32 v252, v143, v252, vcc
    s_mul_i32 s56, s48, 6
    s_add_u32 s56, s56, 64
    v_add_u32 v141, s56, v140
    v_add_u32 v139, s66, v141
    v_bfe_u32 v142, v141, 1, 3
    v_and_b32 v143, 7, v254
    v_xor_b32 v142, v142, v143
    v_lshlrev_b32 v142, 4, v142
    v_mul_u32_u24 v253, 2560, v139
    v_add3_u32 v253, v253, v142, s63
    s_mov_b32 s61, -1
    s_cmp_eq_u32 s48, 0
    s_cselect_b32 s60, 0xffffff00, -1
    s_mul_i32 s75, s48, 768
    s_lshl_b32 s57, s49, 5
    s_add_u32 s56, s57, s53
    s_lshl_b32 s56, s56, 8
    s_lshl_b32 s57, s52, 2
    s_add_u32 s56, s56, s57
    s_add_u32 s78, s56, 12599296
    s_mov_b32 s64, 0
    s_add_u32 m0, s54, 32768
    s_mov_b64 exec, s[60:61]
    buffer_load_dwordx4 v252, s[24:27], s64 offen lds
    s_mov_b64 exec, -1
    s_mov_b32 s64, 0
    s_add_u32 m0, s75, 40960
    s_mov_b32 exec_hi, 0xffff
    buffer_load_dwordx4 v253, s[24:27], s64 offen lds
    s_mov_b32 exec_hi, -1
    s_mov_b32 s36, s22
    s_and_b32 s37, s23, 0xffff
    s_mov_b32 s38, 12845056
    s_mov_b32 s39, 0x20000
    s_mov_b32 s40, s20
    s_and_b32 s41, s21, 0xffff
    s_mov_b32 s42, 256
    s_mov_b32 s43, 0x20000
    s_or_b32 s56, s2, s48
    s_cbranch_scc1 .L20_para
    s_memrealtime s[56:57]
    s_waitcnt lgkmcnt(0)
    s_lshl_b32 s56, s56, 1
    s_or_b32 s56, s56, 1
    v_mov_b32 v152, s56
    s_mov_b64 exec, 1
    buffer_store_dword v152, off, s[40:43], 0 sc1
    s_mov_b64 exec, -1
.L20_para:
    s_add_u32 m0, s54, 8192
    s_mov_b32 s65, 98304
    buffer_load_dwordx4 v251, s[28:31], s65 offen lds
    v_and_b32 v140, 15, v254
    v_lshrrev_b32 v141, 4, v254
    v_bfe_u32 v142, v254, 1, 3
    v_xor_b32 v142, v142, v141
    v_lshlrev_b32 v142, 4, v142
    v_lshl_or_b32 v248, v140, 7, v142
    v_xor_b32 v249, 64, v248
    v_bfe_u32 v142, v254, 2, 2
    v_lshl_add_u32 v143, v141, 3, v142
    v_lshlrev_b32 v250, 8, v143
    v_and_b32 v143, 1, v141
    v_lshl_or_b32 v142, v143, 2, v142
    v_xor_b32 v142, s48, v142
    v_lshl_add_u32 v250, v142, 5, v250
    v_and_b32 v142, 3, v254
    v_lshl_add_u32 v250, v142, 3, v250
    v_mov_b32 v140, 1065369472
    v_and_b32 v141, 31, v254
    v_lshlrev_b32 v141, 2, v141
    v_add_u32 v142, 47104, v141
    s_add_u32 m0, s54, 24576
    s_mov_b32 s65, 98304
    buffer_load_dwordx4 v251, s[32:35], s65 offen lds
    v_add_u32 v143, 94208, v141
    ds_write_b32 v141, v140 offset:32768
    ds_write_b32 v142, v140 offset:32768
    ds_write_b32 v143, v140 offset:32768
    v_mov_b32 v142, 0
    v_and_b32 v141, 15, v254
    v_lshlrev_b32 v141, 2, v141
    v_add_u32 v141, 163776, v141
    ds_write_b32 v141, v142
    s_mul_i32 s56, s2, 5
    s_add_u32 s56, s56, s48
    s_waitcnt vmcnt(8)
    v_lshlrev_b32 v50, 16, v40
    s_sub_u32 s56, s56, 560
    s_cmp_ge_u32 s48, 5
    s_cselect_b32 s56, 680, s56
    v_and_b32 v51, 0xffff0000, v40
    s_min_u32 s56, s56, 680
    s_mul_i32 s67, s56, 6554
    v_lshlrev_b32 v52, 16, v41
    s_lshr_b32 s67, s67, 16
    s_mul_i32 s68, s67, 10
    s_mov_b32 s64, 128
    s_add_u32 m0, s54, 79872
    s_mov_b64 exec, s[60:61]
    buffer_load_dwordx4 v252, s[24:27], s64 offen lds
    s_mov_b64 exec, -1
    v_and_b32 v53, 0xffff0000, v41
    s_sub_u32 s68, s56, s68
    v_lshlrev_b32 v54, 16, v42
    s_sub_u32 s56, s67, 48
    s_mul_i32 s57, s56, 52
    v_and_b32 v55, 0xffff0000, v42
    s_lshr_b32 s57, s57, 8
    s_mul_i32 s73, s57, 5
    v_lshlrev_b32 v56, 16, v43
    s_sub_u32 s56, s56, s73
    s_mul_i32 s69, s57, 160
    v_and_b32 v57, 0xffff0000, v43
    s_mul_i32 s73, s56, 40
    s_cmp_eq_u32 s56, 4
    s_cselect_b32 s73, 16, s73
    s_cselect_b32 s70, 80, 8
    s_cselect_b32 s71, 40, 4
    v_lshlrev_b32 v58, 16, v44
    s_add_u32 s69, s69, s73
    v_and_b32 v59, 0xffff0000, v44
    s_mov_b32 s64, 128
    s_add_u32 m0, s75, 88064
    s_mov_b32 exec_hi, 0xffff
    buffer_load_dwordx4 v253, s[24:27], s64 offen lds
    s_mov_b32 exec_hi, -1
    s_mov_b32 s73, 1966080
    s_mov_b32 s57, 819200
    v_add_f32 v40, v50, v51
    s_lshl_b32 s56, s67, 5
    s_cmp_lt_u32 s67, 48
    s_cselect_b32 s69, s56, s69
    s_cselect_b32 s70, 16, s70
    s_cselect_b32 s71, 4, s71
    s_cselect_b32 s72, 8, 20
    s_cselect_b32 s44, s16, s8
    s_cselect_b32 s45, s17, s9
    s_cselect_b32 s46, s73, s57
    v_add_f32 v41, v52, v53
    s_and_b32 s45, s45, 0xffff
    s_mov_b32 s47, 0x20000
    v_add_f32 v42, v54, v55
    v_lshrrev_b32 v112, 5, v254
    v_add_f32 v43, v56, v57
    v_mul_lo_u32 v112, v112, s72
    v_add_f32 v44, v58, v59
    s_add_u32 m0, s54, 47104
    s_mov_b32 s65, 196608
    buffer_load_dwordx4 v251, s[28:31], s65 offen lds
    v_bfe_u32 v113, v254, 3, 2
    v_add_f32 v40, v40, v41
    v_add_u32 v112, v112, v113
    v_add_f32 v42, v42, v43
    v_mul_u32_u24 v112, 1280, v112
    v_add_f32 v40, v40, v44
    v_and_b32 v113, 7, v254
    v_add_f32 v66, v40, v42
    v_lshl_add_u32 v112, v113, 4, v112
    s_nop 0
    v_add_f32_dpp v66, v66, v66 quad_perm:[1,0,3,2] row_mask:0xf bank_mask:0xf
    s_lshl_b32 s56, s68, 7
    v_add_u32 v112, s56, v112
    v_add_f32_dpp v66, v66, v66 quad_perm:[2,3,0,1] row_mask:0xf bank_mask:0xf
    s_mul_i32 s69, s69, 1280
    s_mul_i32 s70, s70, 1280
    v_add_f32_dpp v66, v66, v66 row_half_mirror row_mask:0xf bank_mask:0xf
    s_mul_i32 s71, s71, 1280
    s_lshl_b32 s72, s48, 12
    v_add_f32_dpp v66, v66, v66 row_mirror row_mask:0xf bank_mask:0xf
    s_add_u32 s72, s72, 141312
    s_add_u32 s70, s70, s69
    s_add_u32 m0, s54, 63488
    s_mov_b32 s65, 196608
    buffer_load_dwordx4 v251, s[32:35], s65 offen lds
    v_add_f32_dpp v66, v66, v66 row_bcast:15 row_mask:0xa bank_mask:0xf
    s_mul_i32 s57, s67, 40
    s_lshl_b32 s73, s68, 2
    v_add_f32_dpp v66, v66, v66 row_bcast:31 row_mask:0xc bank_mask:0xf
    s_add_u32 s57, s57, s73
    s_lshl_b32 s57, s57, 10
    v_mul_f32 v66, 0x3acccccd, v66
    s_add_u32 s57, s57, 9437184
    v_lshl_add_u32 v128, v254, 4, s57
    v_readlane_b32 s22, v66, 63
    v_lshrrev_b32 v129, 4, v254
    s_nop 0
    v_subrev_f32 v50, s22, v50
    v_lshlrev_b32 v129, 10, v129
    v_subrev_f32 v51, s22, v51
    v_bfe_u32 v113, v254, 2, 2
    v_subrev_f32 v52, s22, v52
    v_lshl_add_u32 v129, v113, 7, v129
    v_subrev_f32 v53, s22, v53
    v_and_b32 v113, 3, v254
    v_subrev_f32 v54, s22, v54
    s_add_u32 m0, s54, 55296
    s_mov_b32 s65, 294912
    buffer_load_dwordx4 v251, s[28:31], s65 offen lds
    v_lshl_add_u32 v129, v113, 3, v129
    v_subrev_f32 v55, s22, v55
    v_add_u32 v129, s72, v129
    v_subrev_f32 v56, s22, v56
    s_lshr_b32 s58, s2, 2
    s_lshl_b32 s58, s58, 5
    v_subrev_f32 v57, s22, v57
    s_and_b32 s57, s2, 3
    s_lshl_b32 s57, s57, 2
    v_subrev_f32 v58, s22, v58
    s_add_u32 s58, s58, s57
    s_mov_b32 s57, 2130706432
    v_subrev_f32 v59, s22, v59
    s_cmp_eq_u32 s48, 0
    s_cselect_b32 s57, 12615680, s57
    s_cselect_b64 s[76:77], -1, 0
    v_lshl_add_u32 v148, v254, 5, s57
    v_mul_f32 v66, v50, v50
    v_mul_f32 v67, v51, v51
    v_fmac_f32 v66, v52, v52
    s_add_u32 m0, s54, 71680
    s_mov_b32 s65, 294912
    buffer_load_dwordx4 v251, s[32:35], s65 offen lds
    v_fmac_f32 v67, v53, v53
    v_fmac_f32 v66, v54, v54
    v_fmac_f32 v67, v55, v55
    v_fmac_f32 v66, v56, v56
    v_fmac_f32 v67, v57, v57
    v_fmac_f32 v66, v58, v58
    v_fmac_f32 v67, v59, v59
    v_add_f32 v66, v66, v67
    s_nop 1
    v_add_f32_dpp v66, v66, v66 quad_perm:[1,0,3,2] row_mask:0xf bank_mask:0xf
    s_nop 1
    v_add_f32_dpp v66, v66, v66 quad_perm:[2,3,0,1] row_mask:0xf bank_mask:0xf
    s_nop 1
    v_add_f32_dpp v66, v66, v66 row_half_mirror row_mask:0xf bank_mask:0xf
    s_nop 1
    v_add_f32_dpp v66, v66, v66 row_mirror row_mask:0xf bank_mask:0xf
    s_nop 1
    v_add_f32_dpp v66, v66, v66 row_bcast:15 row_mask:0xa bank_mask:0xf
    s_nop 1
    v_add_f32_dpp v66, v66, v66 row_bcast:31 row_mask:0xc bank_mask:0xf
    v_mul_f32 v66, 0x3acccccd, v66
    s_nop 0
    v_readlane_b32 s23, v66, 63
    v_cvt_pk_bf16_f32 v68, s22, s22
    v_lshlrev_b32 v68, 16, v68
    v_sub_f32 v69, 0, v68
    v_sub_f32 v68, 0, v68
    s_mov_b64 exec, 240
    buffer_load_dword v131, v130, s[28:31], 0 offen
    s_mov_b64 exec, -1
    v_cvt_pk_bf16_f32 v66, s23, s23
    v_lshlrev_b32 v66, 16, v66
    v_add_f32 v66, 0x3727c5ac, v66
    v_cvt_pk_bf16_f32 v66, v66, v66
    v_lshlrev_b32 v66, 16, v66
    v_sqrt_f32 v66, v66
    s_nop 0
    v_cvt_pk_bf16_f32 v66, v66, v66
    v_lshlrev_b32 v66, 16, v66
    v_rcp_f32 v70, v66
    s_nop 0
    v_mul_f32 v71, v70, v70
    s_lshl_b32 s59, s49, 10
    s_add_u32 s55, s59, s55
    s_lshl_b32 s55, s55, 4
    s_add_u32 s55, s55, 12812288
    s_mov_b64 exec, 240
    buffer_load_dword v131, v130, s[32:35], 0 offen
    s_mov_b64 exec, -1
    s_cmp_ge_u32 s67, 68
    s_cbranch_scc1 .L21_para
    s_add_u32 m0, s72, 0
    s_add_u32 s64, s69, 0
    buffer_load_dwordx4 v112, s[44:47], s64 offen lds
    s_add_u32 m0, s72, 1024
    s_add_u32 s64, s69, s71
    buffer_load_dwordx4 v112, s[44:47], s64 offen lds
    s_add_u32 m0, s72, 2048
    s_add_u32 s64, s70, 0
    buffer_load_dwordx4 v112, s[44:47], s64 offen lds
    s_add_u32 m0, s72, 3072
    s_add_u32 s64, s70, s71
    buffer_load_dwordx4 v112, s[44:47], s64 offen lds
.L22_para:
    s_waitcnt vmcnt(12) lgkmcnt(0)
    s_barrier
    ds_read_b64_tr_b16 v[0:1], v250 offset:0
    ds_read_b64_tr_b16 v[2:3], v250 offset:1024
    ds_read_b64_tr_b16 v[4:5], v250 offset:16384
    ds_read_b64_tr_b16 v[6:7], v250 offset:17408
    ds_read_b128 v[216:219], v248 offset:32768
    ds_read_b128 v[220:223], v248 offset:34816
    ds_read_b128 v[224:227], v248 offset:36864
    s_waitcnt lgkmcnt(2)
    v_mfma_f32_16x16x32_bf16 v[160:163], v[0:3], v[216:219], 0
    ds_read_b128 v[228:231], v248 offset:38912
    v_mfma_f32_16x16x32_bf16 v[164:167], v[4:7], v[216:219], 0
    ds_read_b128 v[232:235], v248 offset:40960
    s_mov_b32 s64, 256
    s_add_u32 m0, s54, 126976
    s_mov_b64 exec, s[60:61]
    buffer_load_dwordx4 v252, s[24:27], s64 offen lds
    s_mov_b64 exec, -1
    s_waitcnt lgkmcnt(3)
    v_mfma_f32_16x16x32_bf16 v[168:171], v[0:3], v[220:223], 0
    ds_read_b128 v[236:239], v248 offset:43008
    v_mfma_f32_16x16x32_bf16 v[172:175], v[4:7], v[220:223], 0
    ds_read_b128 v[240:243], v248 offset:45056
    s_waitcnt lgkmcnt(3)
    v_mfma_f32_16x16x32_bf16 v[176:179], v[0:3], v[224:227], 0
    ds_read_b64_tr_b16 v[8:9], v250 offset:8192
    v_mfma_f32_16x16x32_bf16 v[180:183], v[4:7], v[224:227], 0
    ds_read_b64_tr_b16 v[10:11], v250 offset:9216
    s_mov_b32 s64, 256
    s_add_u32 m0, s75, 135168
    s_mov_b32 exec_hi, 0xffff
    buffer_load_dwordx4 v253, s[24:27], s64 offen lds
    s_mov_b32 exec_hi, -1
    v_mfma_f32_16x16x32_bf16 v[184:187], v[0:3], v[228:231], 0
    ds_read_b64_tr_b16 v[12:13], v250 offset:24576
    v_mfma_f32_16x16x32_bf16 v[188:191], v[4:7], v[228:231], 0
    ds_read_b64_tr_b16 v[14:15], v250 offset:25600
    s_waitcnt lgkmcnt(6)
    v_mfma_f32_16x16x32_bf16 v[192:195], v[0:3], v[232:235], 0
    ds_read_b128 v[216:219], v249 offset:32768
    v_mfma_f32_16x16x32_bf16 v[196:199], v[4:7], v[232:235], 0
    ds_read_b128 v[220:223], v249 offset:34816
    s_add_u32 m0, s54, 94208
    s_mov_b32 s65, 393216
    buffer_load_dwordx4 v251, s[28:31], s65 offen lds
    s_waitcnt lgkmcnt(7)
    v_mfma_f32_16x16x32_bf16 v[200:203], v[0:3], v[236:239], 0
    ds_read_b128 v[224:227], v249 offset:36864
    v_mfma_f32_16x16x32_bf16 v[204:207], v[4:7], v[236:239], 0
    ds_read_b128 v[228:231], v249 offset:38912
    s_waitcnt lgkmcnt(3)
    v_mfma_f32_16x16x32_bf16 v[208:211], v[0:3], v[240:243], 0
    ds_read_b128 v[232:235], v249 offset:40960
    v_mfma_f32_16x16x32_bf16 v[212:215], v[4:7], v[240:243], 0
    ds_read_b128 v[236:239], v249 offset:43008
    s_add_u32 m0, s54, 110592
    s_mov_b32 s65, 393216
    buffer_load_dwordx4 v251, s[32:35], s65 offen lds
    v_mfma_f32_16x16x32_bf16 v[160:163], v[8:11], v[216:219], v[160:163]
    ds_read_b128 v[240:243], v249 offset:45056
    v_mfma_f32_16x16x32_bf16 v[164:167], v[12:15], v[216:219], v[164:167]
    s_waitcnt lgkmcnt(4)
    v_mfma_f32_16x16x32_bf16 v[168:171], v[8:11], v[220:223], v[168:171]
    v_mfma_f32_16x16x32_bf16 v[172:175], v[12:15], v[220:223], v[172:175]
    s_add_u32 m0, s54, 102400
    s_mov_b32 s65, 491520
    buffer_load_dwordx4 v251, s[28:31], s65 offen lds
    s_add_u32 m0, s54, 118784
    s_mov_b32 s65, 491520
    buffer_load_dwordx4 v251, s[32:35], s65 offen lds
    s_waitcnt vmcnt(12) lgkmcnt(0)
    s_barrier
    v_mfma_f32_16x16x32_bf16 v[176:179], v[8:11], v[224:227], v[176:179]
    v_add_u32 v250, 47104, v250
    v_add_u32 v248, 47104, v248
    v_add_u32 v249, 47104, v249
    ds_read_b64_tr_b16 v[16:17], v250 offset:0
    v_mfma_f32_16x16x32_bf16 v[180:183], v[12:15], v[224:227], v[180:183]
    ds_read_b64_tr_b16 v[18:19], v250 offset:1024
    s_mov_b64 exec, 16128
    buffer_load_dword v131, v130, s[28:31], 0 offen
    s_mov_b64 exec, -1
    v_mfma_f32_16x16x32_bf16 v[184:187], v[8:11], v[228:231], v[184:187]
    ds_read_b64_tr_b16 v[20:21], v250 offset:16384
    v_mfma_f32_16x16x32_bf16 v[188:191], v[12:15], v[228:231], v[188:191]
    ds_read_b64_tr_b16 v[22:23], v250 offset:17408
    v_mfma_f32_16x16x32_bf16 v[192:195], v[8:11], v[232:235], v[192:195]
    ds_read_b128 v[216:219], v248 offset:32768
    s_mov_b64 exec, 16128
    buffer_load_dword v131, v130, s[32:35], 0 offen
    s_mov_b64 exec, -1
    v_mfma_f32_16x16x32_bf16 v[196:199], v[12:15], v[232:235], v[196:199]
    ds_read_b128 v[220:223], v248 offset:34816
    v_mfma_f32_16x16x32_bf16 v[200:203], v[8:11], v[236:239], v[200:203]
    ds_read_b128 v[224:227], v248 offset:36864
    v_mfma_f32_16x16x32_bf16 v[204:207], v[12:15], v[236:239], v[204:207]
    ds_read_b128 v[228:231], v248 offset:38912
    s_mov_b64 exec, 1
    buffer_store_dwordx4 v[68:71], off, s[36:39], s55 sc1
    s_mov_b64 exec, -1
    v_mfma_f32_16x16x32_bf16 v[208:211], v[8:11], v[240:243], v[208:211]
    ds_read_b128 v[232:235], v248 offset:40960
    v_mfma_f32_16x16x32_bf16 v[212:215], v[12:15], v[240:243], v[212:215]
    ds_read_b128 v[236:239], v248 offset:43008
    s_waitcnt lgkmcnt(4)
    v_mfma_f32_16x16x32_bf16 v[160:163], v[16:19], v[216:219], v[160:163]
    ds_read_b128 v[240:243], v248 offset:45056
    s_mov_b32 s64, 384
    s_add_u32 m0, s54, 32768
    s_mov_b64 exec, s[60:61]
    buffer_load_dwordx4 v252, s[24:27], s64 offen lds
    s_mov_b64 exec, -1
    v_mfma_f32_16x16x32_bf16 v[164:167], v[20:23], v[216:219], v[164:167]
    ds_read_b64_tr_b16 v[24:25], v250 offset:8192
    v_mfma_f32_16x16x32_bf16 v[168:171], v[16:19], v[220:223], v[168:171]
    ds_read_b64_tr_b16 v[26:27], v250 offset:9216
    v_mfma_f32_16x16x32_bf16 v[172:175], v[20:23], v[220:223], v[172:175]
    ds_read_b64_tr_b16 v[28:29], v250 offset:24576
    s_mov_b32 s64, 384
    s_add_u32 m0, s75, 40960
    s_mov_b32 exec_hi, 0xffff
    buffer_load_dwordx4 v253, s[24:27], s64 offen lds
    s_mov_b32 exec_hi, -1
    s_waitcnt lgkmcnt(6)
    v_mfma_f32_16x16x32_bf16 v[176:179], v[16:19], v[224:227], v[176:179]
    ds_read_b64_tr_b16 v[30:31], v250 offset:25600
    v_mfma_f32_16x16x32_bf16 v[180:183], v[20:23], v[224:227], v[180:183]
    ds_read_b128 v[216:219], v249 offset:32768
    v_mfma_f32_16x16x32_bf16 v[184:187], v[16:19], v[228:231], v[184:187]
    ds_read_b128 v[220:223], v249 offset:34816
    s_add_u32 m0, s54, 0
    s_mov_b32 s65, 589824
    buffer_load_dwordx4 v251, s[28:31], s65 offen lds
    v_mfma_f32_16x16x32_bf16 v[188:191], v[20:23], v[228:231], v[188:191]
    ds_read_b128 v[224:227], v249 offset:36864
    s_waitcnt lgkmcnt(8)
    v_mfma_f32_16x16x32_bf16 v[192:195], v[16:19], v[232:235], v[192:195]
    ds_read_b128 v[228:231], v249 offset:38912
    v_mfma_f32_16x16x32_bf16 v[196:199], v[20:23], v[232:235], v[196:199]
    ds_read_b128 v[232:235], v249 offset:40960
    s_add_u32 m0, s54, 16384
    s_mov_b32 s65, 589824
    buffer_load_dwordx4 v251, s[32:35], s65 offen lds
    v_mfma_f32_16x16x32_bf16 v[200:203], v[16:19], v[236:239], v[200:203]
    v_mfma_f32_16x16x32_bf16 v[204:207], v[20:23], v[236:239], v[204:207]
    ds_read_b128 v[236:239], v249 offset:43008
    s_waitcnt lgkmcnt(5)
    v_mfma_f32_16x16x32_bf16 v[208:211], v[16:19], v[240:243], v[208:211]
    s_add_u32 m0, s54, 8192
    s_mov_b32 s65, 688128
    buffer_load_dwordx4 v251, s[28:31], s65 offen lds
    v_mfma_f32_16x16x32_bf16 v[212:215], v[20:23], v[240:243], v[212:215]
    ds_read_b128 v[240:243], v249 offset:45056
    v_mfma_f32_16x16x32_bf16 v[160:163], v[24:27], v[216:219], v[160:163]
    v_mfma_f32_16x16x32_bf16 v[164:167], v[28:31], v[216:219], v[164:167]
    s_add_u32 m0, s54, 24576
    s_mov_b32 s65, 688128
    buffer_load_dwordx4 v251, s[32:35], s65 offen lds
    s_waitcnt lgkmcnt(4)
    v_mfma_f32_16x16x32_bf16 v[168:171], v[24:27], v[220:223], v[168:171]
    v_mfma_f32_16x16x32_bf16 v[172:175], v[28:31], v[220:223], v[172:175]
    s_waitcnt vmcnt(9) lgkmcnt(0)
    s_barrier
    v_mfma_f32_16x16x32_bf16 v[176:179], v[24:27], v[224:227], v[176:179]
    v_add_u32 v250, 47104, v250
    v_add_u32 v248, 47104, v248
    v_add_u32 v249, 47104, v249
    ds_read_b64_tr_b16 v[32:33], v250 offset:0
    s_cmp_ge_u32 s67, 68
    s_cbranch_scc1 .L23_para
    ds_read_b64_tr_b16 v[112:113], v129 offset:0
    ds_read_b64_tr_b16 v[114:115], v129 offset:512
    ds_read_b64_tr_b16 v[116:117], v129 offset:32
    ds_read_b64_tr_b16 v[118:119], v129 offset:544
    ds_read_b64_tr_b16 v[120:121], v129 offset:64
    ds_read_b64_tr_b16 v[122:123], v129 offset:576
    ds_read_b64_tr_b16 v[124:125], v129 offset:96
    ds_read_b64_tr_b16 v[126:127], v129 offset:608
.L23_para:
    v_mfma_f32_16x16x32_bf16 v[180:183], v[28:31], v[224:227], v[180:183]
    ds_read_b64_tr_b16 v[34:35], v250 offset:1024
    s_mov_b32 s64, 512
    s_add_u32 m0, s54, 79872
    s_mov_b64 exec, s[60:61]
    buffer_load_dwordx4 v252, s[24:27], s64 offen lds
    s_mov_b64 exec, -1
    v_mfma_f32_16x16x32_bf16 v[184:187], v[24:27], v[228:231], v[184:187]
    ds_read_b64_tr_b16 v[36:37], v250 offset:16384
    v_mfma_f32_16x16x32_bf16 v[188:191], v[28:31], v[228:231], v[188:191]
    ds_read_b64_tr_b16 v[38:39], v250 offset:17408
    v_mfma_f32_16x16x32_bf16 v[192:195], v[24:27], v[232:235], v[192:195]
    ds_read_b128 v[216:219], v248 offset:32768
    v_mfma_f32_16x16x32_bf16 v[196:199], v[28:31], v[232:235], v[196:199]
    ds_read_b128 v[220:223], v248 offset:34816
    s_mov_b32 s64, 512
    s_add_u32 m0, s75, 88064
    s_mov_b32 exec_hi, 0xffff
    buffer_load_dwordx4 v253, s[24:27], s64 offen lds
    s_mov_b32 exec_hi, -1
    v_mfma_f32_16x16x32_bf16 v[200:203], v[24:27], v[236:239], v[200:203]
    ds_read_b128 v[224:227], v248 offset:36864
    v_mfma_f32_16x16x32_bf16 v[204:207], v[28:31], v[236:239], v[204:207]
    ds_read_b128 v[228:231], v248 offset:38912
    v_mfma_f32_16x16x32_bf16 v[208:211], v[24:27], v[240:243], v[208:211]
    ds_read_b128 v[232:235], v248 offset:40960
    v_mfma_f32_16x16x32_bf16 v[212:215], v[28:31], v[240:243], v[212:215]
    ds_read_b128 v[236:239], v248 offset:43008
    s_add_u32 m0, s54, 47104
    s_mov_b32 s65, 786432
    buffer_load_dwordx4 v251, s[28:31], s65 offen lds
    s_waitcnt lgkmcnt(4)
    v_mfma_f32_16x16x32_bf16 v[160:163], v[32:35], v[216:219], v[160:163]
    ds_read_b128 v[240:243], v248 offset:45056
    v_mfma_f32_16x16x32_bf16 v[164:167], v[36:39], v[216:219], v[164:167]
    ds_read_b64_tr_b16 v[40:41], v250 offset:8192
    v_mfma_f32_16x16x32_bf16 v[168:171], v[32:35], v[220:223], v[168:171]
    ds_read_b64_tr_b16 v[42:43], v250 offset:9216
    v_mfma_f32_16x16x32_bf16 v[172:175], v[36:39], v[220:223], v[172:175]
    ds_read_b64_tr_b16 v[44:45], v250 offset:24576
    s_add_u32 m0, s54, 63488
    s_mov_b32 s65, 786432
    buffer_load_dwordx4 v251, s[32:35], s65 offen lds
    s_waitcnt lgkmcnt(6)
    v_mfma_f32_16x16x32_bf16 v[176:179], v[32:35], v[224:227], v[176:179]
    ds_read_b64_tr_b16 v[46:47], v250 offset:25600
    v_mfma_f32_16x16x32_bf16 v[180:183], v[36:39], v[224:227], v[180:183]
    ds_read_b128 v[216:219], v249 offset:32768
    v_mfma_f32_16x16x32_bf16 v[184:187], v[32:35], v[228:231], v[184:187]
    ds_read_b128 v[220:223], v249 offset:34816
    v_mfma_f32_16x16x32_bf16 v[188:191], v[36:39], v[228:231], v[188:191]
    ds_read_b128 v[224:227], v249 offset:36864
    s_add_u32 m0, s54, 55296
    s_mov_b32 s65, 884736
    buffer_load_dwordx4 v251, s[28:31], s65 offen lds
    s_waitcnt lgkmcnt(8)
    v_mfma_f32_16x16x32_bf16 v[192:195], v[32:35], v[232:235], v[192:195]
    ds_read_b128 v[228:231], v249 offset:38912
    v_mfma_f32_16x16x32_bf16 v[196:199], v[36:39], v[232:235], v[196:199]
    ds_read_b128 v[232:235], v249 offset:40960
    v_mfma_f32_16x16x32_bf16 v[200:203], v[32:35], v[236:239], v[200:203]
    v_mfma_f32_16x16x32_bf16 v[204:207], v[36:39], v[236:239], v[204:207]
    ds_read_b128 v[236:239], v249 offset:43008
    s_add_u32 m0, s54, 71680
    s_mov_b32 s65, 884736
    buffer_load_dwordx4 v251, s[32:35], s65 offen lds
    s_waitcnt lgkmcnt(5)
    v_mfma_f32_16x16x32_bf16 v[208:211], v[32:35], v[240:243], v[208:211]
    v_mfma_f32_16x16x32_bf16 v[212:215], v[36:39], v[240:243], v[212:215]
    ds_read_b128 v[240:243], v249 offset:45056
    v_mfma_f32_16x16x32_bf16 v[160:163], v[40:43], v[216:219], v[160:163]
    v_mfma_f32_16x16x32_bf16 v[164:167], v[44:47], v[216:219], v[164:167]
    s_waitcnt lgkmcnt(4)
    v_mfma_f32_16x16x32_bf16 v[168:171], v[40:43], v[220:223], v[168:171]
    v_mfma_f32_16x16x32_bf16 v[172:175], v[44:47], v[220:223], v[172:175]
    s_waitcnt vmcnt(6) lgkmcnt(0)
    s_barrier
    v_mfma_f32_16x16x32_bf16 v[176:179], v[40:43], v[224:227], v[176:179]
    v_add_u32 v250, -94208, v250
    v_add_u32 v248, -94208, v248
    v_add_u32 v249, -94208, v249
    ds_read_b64_tr_b16 v[48:49], v250 offset:0
    v_and_b32 v132, 15, v254
    v_mfma_f32_16x16x32_bf16 v[180:183], v[44:47], v[224:227], v[180:183]
    ds_read_b64_tr_b16 v[50:51], v250 offset:1024
    s_cmp_ge_u32 s67, 68
    s_cbranch_scc1 .L24_para
    buffer_store_dwordx4 v[112:115], v128, s[36:39], 0 offen offset:0 sc1
    buffer_store_dwordx4 v[116:119], v128, s[36:39], 0 offen offset:1024 sc1
.L25_para:
    v_mfma_f32_16x16x32_bf16 v[184:187], v[40:43], v[228:231], v[184:187]
    ds_read_b64_tr_b16 v[52:53], v250 offset:16384
    v_bfe_u32 v135, v254, 4, 1
    v_mfma_f32_16x16x32_bf16 v[188:191], v[44:47], v[228:231], v[188:191]
    ds_read_b64_tr_b16 v[54:55], v250 offset:17408
    v_lshlrev_b32 v245, 3, v132
    v_mfma_f32_16x16x32_bf16 v[192:195], v[40:43], v[232:235], v[192:195]
    ds_read_b128 v[216:219], v248 offset:32768
    s_mov_b32 s64, 640
    s_add_u32 m0, s54, 126976
    s_mov_b64 exec, s[60:61]
    buffer_load_dwordx4 v252, s[24:27], s64 offen lds
    s_mov_b64 exec, -1
    v_mfma_f32_16x16x32_bf16 v[196:199], v[44:47], v[232:235], v[196:199]
    ds_read_b128 v[220:223], v248 offset:34816
    v_add_u32 v245, 161792, v245
    v_mfma_f32_16x16x32_bf16 v[200:203], v[40:43], v[236:239], v[200:203]
    ds_read_b128 v[224:227], v248 offset:36864
    v_lshrrev_b32 v134, 5, v254
    v_mfma_f32_16x16x32_bf16 v[204:207], v[44:47], v[236:239], v[204:207]
    ds_read_b128 v[228:231], v248 offset:38912
    s_mov_b32 s64, 640
    s_add_u32 m0, s75, 135168
    s_mov_b32 exec_hi, 0xffff
    buffer_load_dwordx4 v253, s[24:27], s64 offen lds
    s_mov_b32 exec_hi, -1
    v_mfma_f32_16x16x32_bf16 v[208:211], v[40:43], v[240:243], v[208:211]
    ds_read_b128 v[232:235], v248 offset:40960
    v_mul_u32_u24 v134, 69632, v134
    v_mfma_f32_16x16x32_bf16 v[212:215], v[44:47], v[240:243], v[212:215]
    ds_read_b128 v[236:239], v248 offset:43008
    v_lshl_or_b32 v134, v135, 8, v134
    s_waitcnt lgkmcnt(4)
    v_mfma_f32_16x16x32_bf16 v[160:163], v[48:51], v[216:219], v[160:163]
    ds_read_b128 v[240:243], v248 offset:45056
    s_add_u32 m0, s54, 94208
    s_mov_b32 s65, 983040
    buffer_load_dwordx4 v251, s[28:31], s65 offen lds
    v_mfma_f32_16x16x32_bf16 v[164:167], v[52:55], v[216:219], v[164:167]
    ds_read_b64_tr_b16 v[56:57], v250 offset:8192
    v_lshl_or_b32 v244, v132, 4, v134
    v_mfma_f32_16x16x32_bf16 v[168:171], v[48:51], v[220:223], v[168:171]
    ds_read_b64_tr_b16 v[58:59], v250 offset:9216
    s_lshl_b32 s69, s52, 2
    s_lshr_b32 s57, s48, 1
    v_mfma_f32_16x16x32_bf16 v[172:175], v[52:55], v[220:223], v[172:175]
    ds_read_b64_tr_b16 v[60:61], v250 offset:24576
    s_cmp_ge_u32 s67, 68
    s_cbranch_scc1 .L26_para
    buffer_store_dwordx4 v[120:123], v128, s[36:39], 0 offen offset:2048 sc1
    buffer_store_dwordx4 v[124:127], v128, s[36:39], 0 offen offset:3072 sc1
.L27_para:
    s_waitcnt lgkmcnt(6)
    v_mfma_f32_16x16x32_bf16 v[176:179], v[48:51], v[224:227], v[176:179]
    ds_read_b64_tr_b16 v[62:63], v250 offset:25600
    s_add_u32 s69, s69, s57
    s_mul_i32 s69, s69, 1024
    v_mfma_f32_16x16x32_bf16 v[180:183], v[52:55], v[224:227], v[180:183]
    ds_read_b128 v[216:219], v249 offset:32768
    s_mul_i32 s57, s49, 4456448
    s_add_u32 s69, s69, s57
    v_mfma_f32_16x16x32_bf16 v[184:187], v[48:51], v[228:231], v[184:187]
    ds_read_b128 v[220:223], v249 offset:34816
    s_add_u32 m0, s54, 110592
    s_mov_b32 s65, 983040
    buffer_load_dwordx4 v251, s[32:35], s65 offen lds
    v_mfma_f32_16x16x32_bf16 v[188:191], v[52:55], v[228:231], v[188:191]
    ds_read_b128 v[224:227], v249 offset:36864
    s_and_b32 s57, s48, 1
    s_lshl_b32 s57, s57, 9
    s_waitcnt lgkmcnt(8)
    v_mfma_f32_16x16x32_bf16 v[192:195], v[48:51], v[232:235], v[192:195]
    ds_read_b128 v[228:231], v249 offset:38912
    s_add_u32 s69, s69, s57
    s_mul_i32 s57, s53, 11
    v_mfma_f32_16x16x32_bf16 v[196:199], v[52:55], v[232:235], v[196:199]
    ds_read_b128 v[232:235], v249 offset:40960
    s_add_u32 m0, s54, 102400
    s_mov_b32 s65, 1081344
    buffer_load_dwordx4 v251, s[28:31], s65 offen lds
    v_mfma_f32_16x16x32_bf16 v[200:203], v[48:51], v[236:239], v[200:203]
    s_add_u32 s57, s57, 959
    v_add_u32 v134, s57, v132
    v_mfma_f32_16x16x32_bf16 v[204:207], v[52:55], v[236:239], v[204:207]
    ds_read_b128 v[236:239], v249 offset:43008
    v_lshrrev_b32 v246, 4, v134
    s_waitcnt lgkmcnt(5)
    v_mfma_f32_16x16x32_bf16 v[208:211], v[48:51], v[240:243], v[208:211]
    s_add_u32 m0, s54, 118784
    s_mov_b32 s65, 1081344
    buffer_load_dwordx4 v251, s[32:35], s65 offen lds
    v_mfma_f32_16x16x32_bf16 v[212:215], v[52:55], v[240:243], v[212:215]
    ds_read_b128 v[240:243], v249 offset:45056
    v_mul_u32_u24 v246, 69632, v246
    v_mfma_f32_16x16x32_bf16 v[160:163], v[56:59], v[216:219], v[160:163]
    v_lshl_or_b32 v246, v135, 8, v246
    v_mfma_f32_16x16x32_bf16 v[164:167], v[60:63], v[216:219], v[164:167]
    v_and_b32 v133, 15, v134
    s_waitcnt lgkmcnt(4)
    v_mfma_f32_16x16x32_bf16 v[168:171], v[56:59], v[220:223], v[168:171]
    v_lshl_or_b32 v246, v133, 4, v246
    v_mfma_f32_16x16x32_bf16 v[172:175], v[60:63], v[220:223], v[172:175]
    v_add_u32 v246, s69, v246
    s_waitcnt vmcnt(10) lgkmcnt(0)
    s_barrier
    v_mfma_f32_16x16x32_bf16 v[176:179], v[56:59], v[224:227], v[176:179]
    v_add_u32 v250, 47104, v250
    v_add_u32 v248, 47104, v248
    v_add_u32 v249, 47104, v249
    ds_read_b64_tr_b16 v[64:65], v250 offset:0
    v_mov_b32 v133, 2130706432
    v_mfma_f32_16x16x32_bf16 v[180:183], v[60:63], v[224:227], v[180:183]
    ds_read_b64_tr_b16 v[66:67], v250 offset:1024
    buffer_load_dword v144, off, s[40:43], 0 sc1
    v_mfma_f32_16x16x32_bf16 v[184:187], v[56:59], v[228:231], v[184:187]
    ds_read_b64_tr_b16 v[68:69], v250 offset:16384
    v_add_u32 v132, -1, v132
    v_mfma_f32_16x16x32_bf16 v[188:191], v[60:63], v[228:231], v[188:191]
    ds_read_b64_tr_b16 v[70:71], v250 offset:17408
    v_cmp_gt_u32 vcc, 11, v132
    v_mfma_f32_16x16x32_bf16 v[192:195], v[56:59], v[232:235], v[192:195]
    ds_read_b128 v[216:219], v248 offset:32768
    v_cndmask_b32 v246, v133, v246, vcc
    v_mfma_f32_16x16x32_bf16 v[196:199], v[60:63], v[232:235], v[196:199]
    ds_read_b128 v[220:223], v248 offset:34816
    s_mov_b32 s64, 768
    s_add_u32 m0, s54, 32768
    s_mov_b64 exec, s[60:61]
    buffer_load_dwordx4 v252, s[24:27], s64 offen lds
    s_mov_b64 exec, -1
    v_mfma_f32_16x16x32_bf16 v[200:203], v[56:59], v[236:239], v[200:203]
    ds_read_b128 v[224:227], v248 offset:36864
    v_cmp_gt_u32 vcc, 1024, v134
    v_mfma_f32_16x16x32_bf16 v[204:207], v[60:63], v[236:239], v[204:207]
    ds_read_b128 v[228:231], v248 offset:38912
    v_cndmask_b32 v246, v133, v246, vcc
    v_mfma_f32_16x16x32_bf16 v[208:211], v[56:59], v[240:243], v[208:211]
    ds_read_b128 v[232:235], v248 offset:40960
    v_cmp_gt_u32 vcc, 32, v254
    v_mfma_f32_16x16x32_bf16 v[212:215], v[60:63], v[240:243], v[212:215]
    ds_read_b128 v[236:239], v248 offset:43008
    s_mov_b32 s64, 768
    s_add_u32 m0, s75, 40960
    s_mov_b32 exec_hi, 0xffff
    buffer_load_dwordx4 v253, s[24:27], s64 offen lds
    s_mov_b32 exec_hi, -1
    s_waitcnt lgkmcnt(4)
    v_mfma_f32_16x16x32_bf16 v[160:163], v[64:67], v[216:219], v[160:163]
    ds_read_b128 v[240:243], v248 offset:45056
    v_cndmask_b32 v246, v133, v246, vcc
    v_mfma_f32_16x16x32_bf16 v[164:167], v[68:71], v[216:219], v[164:167]
    ds_read_b64_tr_b16 v[72:73], v250 offset:8192
    s_mul_i32 s57, s53, 696320
    s_add_u32 s69, s69, s57
    v_add_u32 v244, s69, v244
    v_mfma_f32_16x16x32_bf16 v[168:171], v[64:67], v[220:223], v[168:171]
    ds_read_b64_tr_b16 v[74:75], v250 offset:9216
    s_mul_i32 s56, s48, 22
    v_lshrrev_b32 v136, 1, v254
    v_mfma_f32_16x16x32_bf16 v[172:175], v[68:71], v[220:223], v[172:175]
    ds_read_b64_tr_b16 v[76:77], v250 offset:24576
    s_add_u32 m0, s54, 0
    s_mov_b32 s65, 1179648
    buffer_load_dwordx4 v251, s[28:31], s65 offen lds
    s_waitcnt lgkmcnt(6)
    v_mfma_f32_16x16x32_bf16 v[176:179], v[64:67], v[224:227], v[176:179]
    ds_read_b64_tr_b16 v[78:79], v250 offset:25600
    v_add_u32 v136, s56, v136
    v_mfma_f32_16x16x32_bf16 v[180:183], v[68:71], v[224:227], v[180:183]
    ds_read_b128 v[216:219], v249 offset:32768
    v_add_u32 v255, s66, v136
    v_mfma_f32_16x16x32_bf16 v[184:187], v[64:67], v[228:231], v[184:187]
    ds_read_b128 v[220:223], v249 offset:34816
    s_mul_i32 s56, s53, 11
    s_add_u32 s56, s56, 959
    v_add_u32 v139, s56, v136
    v_mfma_f32_16x16x32_bf16 v[188:191], v[68:71], v[228:231], v[188:191]
    ds_read_b128 v[224:227], v249 offset:36864
    s_add_u32 m0, s54, 16384
    s_mov_b32 s65, 1179648
    buffer_load_dwordx4 v251, s[32:35], s65 offen lds
    s_waitcnt lgkmcnt(8)
    v_mfma_f32_16x16x32_bf16 v[192:195], v[64:67], v[232:235], v[192:195]
    ds_read_b128 v[228:231], v249 offset:38912
    v_mov_b32 v137, 0x100000
    v_mfma_f32_16x16x32_bf16 v[196:199], v[68:71], v[232:235], v[196:199]
    ds_read_b128 v[232:235], v249 offset:40960
    v_add_u32 v138, -1, v136
    v_mfma_f32_16x16x32_bf16 v[200:203], v[64:67], v[236:239], v[200:203]
    v_cmp_gt_u32 vcc, 11, v138
    v_mfma_f32_16x16x32_bf16 v[204:207], v[68:71], v[236:239], v[204:207]
    ds_read_b128 v[236:239], v249 offset:43008
    s_add_u32 m0, s54, 8192
    s_mov_b32 s65, 1277952
    buffer_load_dwordx4 v251, s[28:31], s65 offen lds
    s_waitcnt lgkmcnt(5)
    v_mfma_f32_16x16x32_bf16 v[208:211], v[64:67], v[240:243], v[208:211]
    v_cndmask_b32 v139, v137, v139, vcc
    v_mfma_f32_16x16x32_bf16 v[212:215], v[68:71], v[240:243], v[212:215]
    ds_read_b128 v[240:243], v249 offset:45056
    v_cmp_gt_u32 vcc, 16, v136
    v_mfma_f32_16x16x32_bf16 v[160:163], v[72:75], v[216:219], v[160:163]
    s_nop 0
    v_cndmask_b32 v255, v255, v139, vcc
    v_mfma_f32_16x16x32_bf16 v[164:167], v[76:79], v[216:219], v[164:167]
    s_add_u32 m0, s54, 24576
    s_mov_b32 s65, 1277952
    buffer_load_dwordx4 v251, s[32:35], s65 offen lds
    s_waitcnt lgkmcnt(4)
    v_mfma_f32_16x16x32_bf16 v[168:171], v[72:75], v[220:223], v[168:171]
    v_cmp_gt_u32 vcc, 1024, v255
    v_mfma_f32_16x16x32_bf16 v[172:175], v[76:79], v[220:223], v[172:175]
    v_and_b32 v138, 1, v254
    s_waitcnt vmcnt(7) lgkmcnt(0)
    s_barrier
    v_mfma_f32_16x16x32_bf16 v[176:179], v[72:75], v[224:227], v[176:179]
    v_add_u32 v250, 47104, v250
    v_add_u32 v248, 47104, v248
    v_add_u32 v249, 47104, v249
    ds_read_b64_tr_b16 v[80:81], v250 offset:0
    v_lshlrev_b32 v138, 3, v138
    v_mfma_f32_16x16x32_bf16 v[180:183], v[76:79], v[224:227], v[180:183]
    ds_read_b64_tr_b16 v[82:83], v250 offset:1024
    s_waitcnt vmcnt(6)
    v_readfirstlane_b32 s20, v144
    s_mov_b32 s59, 0
    s_cmp_eq_u32 s20, 0
    s_cbranch_scc1 .L28_para
.L29_para:
    s_mov_b64 exec, 1
    buffer_store_dword v144, v148, s[36:39], s58 offen sc1
    s_mov_b64 exec, -1
    v_mfma_f32_16x16x32_bf16 v[184:187], v[72:75], v[228:231], v[184:187]
    ds_read_b64_tr_b16 v[84:85], v250 offset:16384
    v_lshl_add_u32 v255, v255, 4, v138
    v_mfma_f32_16x16x32_bf16 v[188:191], v[76:79], v[228:231], v[188:191]
    ds_read_b64_tr_b16 v[86:87], v250 offset:17408
    s_lshl_b32 s56, s49, 14
    s_add_u32 s56, s56, 12812288
    v_add_u32 v255, s56, v255
    v_mfma_f32_16x16x32_bf16 v[192:195], v[72:75], v[232:235], v[192:195]
    ds_read_b128 v[216:219], v248 offset:32768
    v_cndmask_b32 v255, v133, v255, vcc
    v_mfma_f32_16x16x32_bf16 v[196:199], v[76:79], v[232:235], v[196:199]
    ds_read_b128 v[220:223], v248 offset:34816
    s_mov_b32 s64, 896
    s_add_u32 m0, s54, 79872
    s_mov_b64 exec, s[60:61]
    buffer_load_dwordx4 v252, s[24:27], s64 offen lds
    s_mov_b64 exec, -1
    v_mfma_f32_16x16x32_bf16 v[200:203], v[72:75], v[236:239], v[200:203]
    ds_read_b128 v[224:227], v248 offset:36864
    v_lshrrev_b32 v150, 3, v254
    v_mfma_f32_16x16x32_bf16 v[204:207], v[76:79], v[236:239], v[204:207]
    ds_read_b128 v[228:231], v248 offset:38912
    s_lshl_b32 s56, s48, 3
    s_add_u32 s56, s56, 64
    v_add_u32 v150, s56, v150
    v_mfma_f32_16x16x32_bf16 v[208:211], v[72:75], v[240:243], v[208:211]
    ds_read_b128 v[232:235], v248 offset:40960
    v_add_u32 v158, s66, v150
    v_mfma_f32_16x16x32_bf16 v[212:215], v[76:79], v[240:243], v[212:215]
    ds_read_b128 v[236:239], v248 offset:43008
    s_mov_b32 s64, 896
    s_add_u32 m0, s75, 88064
    s_mov_b32 exec_hi, 0xffff
    buffer_load_dwordx4 v253, s[24:27], s64 offen lds
    s_mov_b32 exec_hi, -1
    s_waitcnt lgkmcnt(4)
    v_mfma_f32_16x16x32_bf16 v[160:163], v[80:83], v[216:219], v[160:163]
    ds_read_b128 v[240:243], v248 offset:45056
    v_bfe_u32 v151, v150, 1, 3
    v_mfma_f32_16x16x32_bf16 v[164:167], v[84:87], v[216:219], v[164:167]
    ds_read_b64_tr_b16 v[88:89], v250 offset:8192
    v_and_b32 v157, 7, v254
    v_mfma_f32_16x16x32_bf16 v[168:171], v[80:83], v[220:223], v[168:171]
    ds_read_b64_tr_b16 v[90:91], v250 offset:9216
    v_xor_b32 v151, v151, v157
    v_mfma_f32_16x16x32_bf16 v[172:175], v[84:87], v[220:223], v[172:175]
    ds_read_b64_tr_b16 v[92:93], v250 offset:24576
    s_add_u32 m0, s54, 47104
    s_mov_b32 s65, 1376256
    buffer_load_dwordx4 v251, s[28:31], s65 offen lds
    s_waitcnt lgkmcnt(6)
    v_mfma_f32_16x16x32_bf16 v[176:179], v[80:83], v[224:227], v[176:179]
    ds_read_b64_tr_b16 v[94:95], v250 offset:25600
    v_lshlrev_b32 v151, 4, v151
    v_mfma_f32_16x16x32_bf16 v[180:183], v[84:87], v[224:227], v[180:183]
    ds_read_b128 v[216:219], v249 offset:32768
    v_mul_u32_u24 v159, 2560, v158
    v_mfma_f32_16x16x32_bf16 v[184:187], v[80:83], v[228:231], v[184:187]
    ds_read_b128 v[220:223], v249 offset:34816
    v_add3_u32 v159, v159, v151, s63
    v_mfma_f32_16x16x32_bf16 v[188:191], v[84:87], v[228:231], v[188:191]
    ds_read_b128 v[224:227], v249 offset:36864
    s_add_u32 m0, s54, 63488
    s_mov_b32 s65, 1376256
    buffer_load_dwordx4 v251, s[32:35], s65 offen lds
    s_waitcnt lgkmcnt(8)
    v_mfma_f32_16x16x32_bf16 v[192:195], v[80:83], v[232:235], v[192:195]
    ds_read_b128 v[228:231], v249 offset:38912
    s_mul_i32 s74, s48, 5120
    s_lshl_b32 s68, s48, 11
    v_mfma_f32_16x16x32_bf16 v[196:199], v[84:87], v[232:235], v[196:199]
    ds_read_b128 v[232:235], v249 offset:40960
    s_add_u32 s68, s68, 141312
    v_lshlrev_b32 v247, 4, v254
    v_mfma_f32_16x16x32_bf16 v[200:203], v[80:83], v[236:239], v[200:203]
    s_mul_i32 s66, s48, 176
    s_add_u32 s66, s66, 161792
    v_mfma_f32_16x16x32_bf16 v[204:207], v[84:87], v[236:239], v[204:207]
    ds_read_b128 v[236:239], v249 offset:43008
    s_add_u32 m0, s54, 55296
    s_mov_b32 s65, 1474560
    buffer_load_dwordx4 v251, s[28:31], s65 offen lds
    s_waitcnt lgkmcnt(5)
    v_mfma_f32_16x16x32_bf16 v[208:211], v[80:83], v[240:243], v[208:211]
    v_mfma_f32_16x16x32_bf16 v[212:215], v[84:87], v[240:243], v[212:215]
    ds_read_b128 v[240:243], v249 offset:45056
    v_mfma_f32_16x16x32_bf16 v[160:163], v[88:91], v[216:219], v[160:163]
    v_mfma_f32_16x16x32_bf16 v[164:167], v[92:95], v[216:219], v[164:167]
    s_add_u32 m0, s54, 71680
    s_mov_b32 s65, 1474560
    buffer_load_dwordx4 v251, s[32:35], s65 offen lds
    s_waitcnt lgkmcnt(4)
    v_mfma_f32_16x16x32_bf16 v[168:171], v[88:91], v[220:223], v[168:171]
    v_mfma_f32_16x16x32_bf16 v[172:175], v[92:95], v[220:223], v[172:175]
    s_waitcnt vmcnt(7) lgkmcnt(0)
    s_barrier
    v_mfma_f32_16x16x32_bf16 v[176:179], v[88:91], v[224:227], v[176:179]
    v_add_u32 v250, -94208, v250
    v_add_u32 v248, -94208, v248
    v_add_u32 v249, -94208, v249
    ds_read_b64_tr_b16 v[96:97], v250 offset:0
    s_and_b32 s56, s51, 3
    s_lshl_b32 s3, s50, 2
    v_mfma_f32_16x16x32_bf16 v[180:183], v[92:95], v[224:227], v[180:183]
    ds_read_b64_tr_b16 v[98:99], v250 offset:1024
    s_mov_b32 s64, 1024
    s_add_u32 m0, s54, 126976
    s_mov_b64 exec, s[60:61]
    buffer_load_dwordx4 v252, s[24:27], s64 offen lds
    s_mov_b64 exec, -1
    v_mfma_f32_16x16x32_bf16 v[184:187], v[88:91], v[228:231], v[184:187]
    ds_read_b64_tr_b16 v[100:101], v250 offset:16384
    s_add_u32 s3, s3, s56
    s_lshl_b32 s56, s56, 1
    v_mfma_f32_16x16x32_bf16 v[188:191], v[92:95], v[228:231], v[188:191]
    ds_read_b64_tr_b16 v[102:103], v250 offset:17408
    s_lshr_b32 s1, s51, 2
    s_add_u32 s1, s1, s56
    v_mfma_f32_16x16x32_bf16 v[192:195], v[88:91], v[232:235], v[192:195]
    ds_read_b128 v[216:219], v248 offset:32768
    s_and_b32 s1, s1, 7
    v_mfma_f32_16x16x32_bf16 v[196:199], v[92:95], v[232:235], v[196:199]
    ds_read_b128 v[220:223], v248 offset:34816
    s_mov_b32 s64, 1024
    s_add_u32 m0, s75, 135168
    s_mov_b32 exec_hi, 0xffff
    buffer_load_dwordx4 v253, s[24:27], s64 offen lds
    s_mov_b32 exec_hi, -1
    v_mfma_f32_16x16x32_bf16 v[200:203], v[88:91], v[236:239], v[200:203]
    ds_read_b128 v[224:227], v248 offset:36864
    s_mul_i32 s0, s48, 9
    s_mul_i32 s56, s48, 3
    v_mfma_f32_16x16x32_bf16 v[204:207], v[92:95], v[236:239], v[204:207]
    ds_read_b128 v[228:231], v248 offset:38912
    s_add_u32 s56, s56, 24
    s_min_u32 s0, s0, s56
    v_mfma_f32_16x16x32_bf16 v[208:211], v[88:91], v[240:243], v[208:211]
    ds_read_b128 v[232:235], v248 offset:40960
    s_mul_i32 s79, s0, 40960
    s_mul_i32 s56, s1, 5120
    v_mfma_f32_16x16x32_bf16 v[212:215], v[92:95], v[240:243], v[212:215]
    ds_read_b128 v[236:239], v248 offset:43008
    s_add_u32 m0, s54, 94208
    s_mov_b32 s65, 1572864
    buffer_load_dwordx4 v251, s[28:31], s65 offen lds
    s_waitcnt lgkmcnt(4)
    v_mfma_f32_16x16x32_bf16 v[160:163], v[96:99], v[216:219], v[160:163]
    ds_read_b128 v[240:243], v248 offset:45056
    s_add_u32 s79, s79, s56
    s_add_u32 s79, s79, 9437184
    v_mfma_f32_16x16x32_bf16 v[164:167], v[100:103], v[216:219], v[164:167]
    ds_read_b64_tr_b16 v[104:105], v250 offset:8192
    s_lshr_b32 s16, s3, 1
    s_mul_i32 s8, s16, 10
    v_mfma_f32_16x16x32_bf16 v[168:171], v[96:99], v[220:223], v[168:171]
    ds_read_b64_tr_b16 v[106:107], v250 offset:9216
    s_and_b32 s56, s3, 1
    s_lshl_b32 s56, s56, 1
    v_mfma_f32_16x16x32_bf16 v[172:175], v[100:103], v[220:223], v[172:175]
    ds_read_b64_tr_b16 v[108:109], v250 offset:24576
    s_add_u32 m0, s54, 110592
    s_mov_b32 s65, 1572864
    buffer_load_dwordx4 v251, s[32:35], s65 offen lds
    s_waitcnt lgkmcnt(6)
    v_mfma_f32_16x16x32_bf16 v[176:179], v[96:99], v[224:227], v[176:179]
    ds_read_b64_tr_b16 v[110:111], v250 offset:25600
    s_add_u32 s8, s8, s56
    s_add_u32 s10, s8, 6
    v_mfma_f32_16x16x32_bf16 v[180:183], v[100:103], v[224:227], v[180:183]
    ds_read_b128 v[216:219], v249 offset:32768
    s_sub_u32 s56, s3, 12
    s_mul_i32 s57, s56, 20
    v_mfma_f32_16x16x32_bf16 v[184:187], v[96:99], v[228:231], v[184:187]
    ds_read_b128 v[220:223], v249 offset:34816
    s_add_u32 s57, s57, 4
    s_add_u32 s14, s57, 10
    v_mfma_f32_16x16x32_bf16 v[188:191], v[100:103], v[228:231], v[188:191]
    ds_read_b128 v[224:227], v249 offset:36864
    s_add_u32 m0, s54, 102400
    s_mov_b32 s65, 1671168
    buffer_load_dwordx4 v251, s[28:31], s65 offen lds
    s_waitcnt lgkmcnt(8)
    v_mfma_f32_16x16x32_bf16 v[192:195], v[96:99], v[232:235], v[192:195]
    ds_read_b128 v[228:231], v249 offset:38912
    s_lshl_b32 s56, s56, 1
    s_add_u32 s17, s56, 1
    v_mfma_f32_16x16x32_bf16 v[196:199], v[100:103], v[232:235], v[196:199]
    ds_read_b128 v[232:235], v249 offset:40960
    s_cmp_ge_u32 s3, 12
    s_cselect_b32 s8, s57, s8
    s_cselect_b32 s10, s14, s10
    s_cselect_b32 s17, s17, s16
    s_cselect_b32 s16, s56, s16
    v_mfma_f32_16x16x32_bf16 v[200:203], v[96:99], v[236:239], v[200:203]
    s_cmp_eq_u32 s3, 15
    s_cselect_b32 s8, 60, s8
    s_cselect_b32 s10, 62, s10
    s_cselect_b32 s16, 0, s16
    s_cselect_b32 s17, 5, s17
    v_mfma_f32_16x16x32_bf16 v[204:207], v[100:103], v[236:239], v[204:207]
    ds_read_b128 v[236:239], v249 offset:43008
    s_add_u32 m0, s54, 118784
    s_mov_b32 s65, 1671168
    buffer_load_dwordx4 v251, s[32:35], s65 offen lds
    s_waitcnt lgkmcnt(5)
    v_mfma_f32_16x16x32_bf16 v[208:211], v[96:99], v[240:243], v[208:211]
    s_mul_i32 s14, s8, 54
    s_lshr_b32 s14, s14, 9
    v_mfma_f32_16x16x32_bf16 v[212:215], v[100:103], v[240:243], v[212:215]
    ds_read_b128 v[240:243], v249 offset:45056
    s_mul_i32 s21, s10, 54
    s_add_u32 s21, s21, 81
    v_mfma_f32_16x16x32_bf16 v[160:163], v[104:107], v[216:219], v[160:163]
    s_lshr_b32 s21, s21, 9
    v_mfma_f32_16x16x32_bf16 v[164:167], v[108:111], v[216:219], v[164:167]
    s_mul_i32 s12, s0, 1024
    s_mul_i32 s56, s49, 4456448
    s_waitcnt lgkmcnt(4)
    v_mfma_f32_16x16x32_bf16 v[168:171], v[104:107], v[220:223], v[168:171]
    s_add_u32 s12, s12, s56
    s_mul_i32 s13, s49, 1280
    v_mfma_f32_16x16x32_bf16 v[172:175], v[108:111], v[220:223], v[172:175]
    s_mul_i32 s56, s1, 160
    s_add_u32 s13, s13, s56
    s_waitcnt vmcnt(6) lgkmcnt(0)
    s_barrier
    v_mfma_f32_16x16x32_bf16 v[176:179], v[104:107], v[224:227], v[176:179]
    v_add_u32 v250, 47104, v250
    v_add_u32 v248, 47104, v248
    v_add_u32 v249, 47104, v249
    ds_read_b64_tr_b16 v[112:113], v250 offset:0
    s_lshl_b32 s56, s49, 14
    s_add_u32 s56, s56, 12812300
    v_mfma_f32_16x16x32_bf16 v[180:183], v[108:111], v[224:227], v[180:183]
    ds_read_b64_tr_b16 v[114:115], v250 offset:1024
    s_mov_b32 s64, 1152
    s_add_u32 m0, s54, 32768
    s_mov_b64 exec, s[60:61]
    buffer_load_dwordx4 v252, s[24:27], s64 offen lds
    s_mov_b64 exec, -1
    v_mfma_f32_16x16x32_bf16 v[184:187], v[104:107], v[228:231], v[184:187]
    ds_read_b64_tr_b16 v[116:117], v250 offset:16384
    s_lshl_b32 s55, s10, 8
    s_add_u32 s55, s55, s56
    v_mfma_f32_16x16x32_bf16 v[188:191], v[108:111], v[228:231], v[188:191]
    ds_read_b64_tr_b16 v[118:119], v250 offset:17408
    s_lshl_b32 s57, s8, 8
    s_add_u32 s62, s57, s56
    v_mfma_f32_16x16x32_bf16 v[192:195], v[104:107], v[232:235], v[192:195]
    ds_read_b128 v[216:219], v248 offset:32768
    s_mul_i32 s57, s8, 69632
    s_add_u32 s4, s12, s57
    v_mfma_f32_16x16x32_bf16 v[196:199], v[108:111], v[232:235], v[196:199]
    ds_read_b128 v[220:223], v248 offset:34816
    s_mov_b32 s64, 1152
    s_add_u32 m0, s75, 40960
    s_mov_b32 exec_hi, 0xffff
    buffer_load_dwordx4 v253, s[24:27], s64 offen lds
    s_mov_b32 exec_hi, -1
    v_mfma_f32_16x16x32_bf16 v[200:203], v[104:107], v[236:239], v[200:203]
    ds_read_b128 v[224:227], v248 offset:36864
    s_add_u32 s5, s4, 69632
    s_mul_i32 s57, s8, 40960
    v_mfma_f32_16x16x32_bf16 v[204:207], v[108:111], v[236:239], v[204:207]
    ds_read_b128 v[228:231], v248 offset:38912
    s_add_u32 s8, s13, s57
    s_add_u32 s9, s8, 40960
    v_mfma_f32_16x16x32_bf16 v[208:211], v[104:107], v[240:243], v[208:211]
    ds_read_b128 v[232:235], v248 offset:40960
    s_mul_i32 s57, s10, 69632
    s_add_u32 s6, s12, s57
    v_mfma_f32_16x16x32_bf16 v[212:215], v[108:111], v[240:243], v[212:215]
    ds_read_b128 v[236:239], v248 offset:43008
    s_add_u32 m0, s54, 0
    s_mov_b32 s65, 1769472
    buffer_load_dwordx4 v251, s[28:31], s65 offen lds
    s_waitcnt lgkmcnt(4)
    v_mfma_f32_16x16x32_bf16 v[160:163], v[112:115], v[216:219], v[160:163]
    ds_read_b128 v[240:243], v248 offset:45056
    s_add_u32 s7, s6, 69632
    s_mul_i32 s57, s10, 40960
    v_mfma_f32_16x16x32_bf16 v[164:167], v[116:119], v[216:219], v[164:167]
    ds_read_b64_tr_b16 v[120:121], v250 offset:8192
    s_add_u32 s10, s13, s57
    s_add_u32 s11, s10, 40960
    v_mfma_f32_16x16x32_bf16 v[168:171], v[112:115], v[220:223], v[168:171]
    ds_read_b64_tr_b16 v[122:123], v250 offset:9216
    s_mov_b32 s13, s62
    v_mfma_f32_16x16x32_bf16 v[172:175], v[116:119], v[220:223], v[172:175]
    ds_read_b64_tr_b16 v[124:125], v250 offset:24576
    s_add_u32 m0, s54, 16384
    s_mov_b32 s65, 1769472
    buffer_load_dwordx4 v251, s[32:35], s65 offen lds
    s_waitcnt lgkmcnt(6)
    v_mfma_f32_16x16x32_bf16 v[176:179], v[112:115], v[224:227], v[176:179]
    ds_read_b64_tr_b16 v[126:127], v250 offset:25600
    s_lshl_b32 s56, s48, 1
    s_add_u32 s56, s56, 4
    v_mfma_f32_16x16x32_bf16 v[180:183], v[116:119], v[224:227], v[180:183]
    ds_read_b128 v[216:219], v249 offset:32768
    s_cmp_lt_u32 s48, 4
    s_cselect_b32 s56, 3, s56
    s_cselect_b32 s57, 3072, 0
    s_cselect_b32 s1, s4, s5
    v_mfma_f32_16x16x32_bf16 v[184:187], v[112:115], v[228:231], v[184:187]
    ds_read_b128 v[220:223], v249 offset:34816
    s_add_u32 s1, s1, s57
    s_mul_i32 s58, s56, 1024
    v_mfma_f32_16x16x32_bf16 v[188:191], v[116:119], v[228:231], v[188:191]
    ds_read_b128 v[224:227], v249 offset:36864
    s_add_u32 m0, s54, 8192
    s_mov_b32 s65, 1867776
    buffer_load_dwordx4 v251, s[28:31], s65 offen lds
    s_waitcnt lgkmcnt(8)
    v_mfma_f32_16x16x32_bf16 v[192:195], v[112:115], v[232:235], v[192:195]
    ds_read_b128 v[228:231], v249 offset:38912
    s_mul_i32 s56, s56, 40960
    s_add_u32 s0, s79, s56
    v_mfma_f32_16x16x32_bf16 v[196:199], v[116:119], v[232:235], v[196:199]
    ds_read_b128 v[232:235], v249 offset:40960
    v_mfma_f32_16x16x32_bf16 v[200:203], v[112:115], v[236:239], v[200:203]
    v_mfma_f32_16x16x32_bf16 v[204:207], v[116:119], v[236:239], v[204:207]
    ds_read_b128 v[236:239], v249 offset:43008
    s_add_u32 m0, s54, 24576
    s_mov_b32 s65, 1867776
    buffer_load_dwordx4 v251, s[32:35], s65 offen lds
    s_waitcnt lgkmcnt(5)
    v_mfma_f32_16x16x32_bf16 v[208:211], v[112:115], v[240:243], v[208:211]
    v_mfma_f32_16x16x32_bf16 v[212:215], v[116:119], v[240:243], v[212:215]
    ds_read_b128 v[240:243], v249 offset:45056
    v_mfma_f32_16x16x32_bf16 v[160:163], v[120:123], v[216:219], v[160:163]
    v_mfma_f32_16x16x32_bf16 v[164:167], v[124:127], v[216:219], v[164:167]
    s_waitcnt lgkmcnt(4)
    v_mfma_f32_16x16x32_bf16 v[168:171], v[120:123], v[220:223], v[168:171]
    v_mfma_f32_16x16x32_bf16 v[172:175], v[124:127], v[220:223], v[172:175]
    s_waitcnt vmcnt(6) lgkmcnt(0)
    s_barrier
    v_mfma_f32_16x16x32_bf16 v[176:179], v[120:123], v[224:227], v[176:179]
    v_add_u32 v250, 47104, v250
    v_add_u32 v248, 47104, v248
    v_add_u32 v249, 47104, v249
    v_mov_b32 v252, v159
    ds_read_b64_tr_b16 v[128:129], v250 offset:0
    v_mfma_f32_16x16x32_bf16 v[180:183], v[124:127], v[224:227], v[180:183]
    ds_read_b64_tr_b16 v[130:131], v250 offset:1024
    buffer_load_dwordx4 v[144:147], v148, s[36:39], 0 offen sc1
    v_mfma_f32_16x16x32_bf16 v[184:187], v[120:123], v[228:231], v[184:187]
    ds_read_b64_tr_b16 v[132:133], v250 offset:16384
    v_mfma_f32_16x16x32_bf16 v[188:191], v[124:127], v[228:231], v[188:191]
    ds_read_b64_tr_b16 v[134:135], v250 offset:17408
    v_mfma_f32_16x16x32_bf16 v[192:195], v[120:123], v[232:235], v[192:195]
    ds_read_b128 v[216:219], v248 offset:32768
    v_mfma_f32_16x16x32_bf16 v[196:199], v[124:127], v[232:235], v[196:199]
    ds_read_b128 v[220:223], v248 offset:34816
    s_add_u32 m0, s54, 47104
    s_mov_b32 s64, 122880
    buffer_load_dwordx4 v252, s[24:27], s64 offen lds
    v_mfma_f32_16x16x32_bf16 v[200:203], v[120:123], v[236:239], v[200:203]
    ds_read_b128 v[224:227], v248 offset:36864
    v_mfma_f32_16x16x32_bf16 v[204:207], v[124:127], v[236:239], v[204:207]
    ds_read_b128 v[228:231], v248 offset:38912
    v_mfma_f32_16x16x32_bf16 v[208:211], v[120:123], v[240:243], v[208:211]
    ds_read_b128 v[232:235], v248 offset:40960
    v_mfma_f32_16x16x32_bf16 v[212:215], v[124:127], v[240:243], v[212:215]
    ds_read_b128 v[236:239], v248 offset:43008
    s_add_u32 m0, s54, 55296
    s_mov_b32 s64, 123008
    buffer_load_dwordx4 v252, s[24:27], s64 offen lds
    s_waitcnt lgkmcnt(4)
    v_mfma_f32_16x16x32_bf16 v[160:163], v[128:131], v[216:219], v[160:163]
    ds_read_b128 v[240:243], v248 offset:45056
    v_mfma_f32_16x16x32_bf16 v[164:167], v[132:135], v[216:219], v[164:167]
    ds_read_b64_tr_b16 v[136:137], v250 offset:8192
    v_mfma_f32_16x16x32_bf16 v[168:171], v[128:131], v[220:223], v[168:171]
    ds_read_b64_tr_b16 v[138:139], v250 offset:9216
    v_mfma_f32_16x16x32_bf16 v[172:175], v[132:135], v[220:223], v[172:175]
    ds_read_b64_tr_b16 v[140:141], v250 offset:24576
    s_add_u32 m0, s54, 63488
    s_mov_b32 s64, 123136
    buffer_load_dwordx4 v252, s[24:27], s64 offen lds
    s_waitcnt lgkmcnt(6)
    v_mfma_f32_16x16x32_bf16 v[176:179], v[128:131], v[224:227], v[176:179]
    ds_read_b64_tr_b16 v[142:143], v250 offset:25600
    v_mfma_f32_16x16x32_bf16 v[180:183], v[132:135], v[224:227], v[180:183]
    ds_read_b128 v[216:219], v249 offset:32768
    v_mfma_f32_16x16x32_bf16 v[184:187], v[128:131], v[228:231], v[184:187]
    ds_read_b128 v[220:223], v249 offset:34816
    v_mfma_f32_16x16x32_bf16 v[188:191], v[132:135], v[228:231], v[188:191]
    ds_read_b128 v[224:227], v249 offset:36864
    s_add_u32 m0, s54, 71680
    s_mov_b32 s64, 123264
    buffer_load_dwordx4 v252, s[24:27], s64 offen lds
    s_waitcnt lgkmcnt(8)
    v_mfma_f32_16x16x32_bf16 v[192:195], v[128:131], v[232:235], v[192:195]
    ds_read_b128 v[228:231], v249 offset:38912
    v_mfma_f32_16x16x32_bf16 v[196:199], v[132:135], v[232:235], v[196:199]
    ds_read_b128 v[232:235], v249 offset:40960
    v_mfma_f32_16x16x32_bf16 v[200:203], v[128:131], v[236:239], v[200:203]
    v_mfma_f32_16x16x32_bf16 v[204:207], v[132:135], v[236:239], v[204:207]
    ds_read_b128 v[236:239], v249 offset:43008
    s_add_u32 m0, s54, 79872
    s_mov_b32 s64, 123392
    buffer_load_dwordx4 v252, s[24:27], s64 offen lds
    s_waitcnt lgkmcnt(5)
    v_mfma_f32_16x16x32_bf16 v[208:211], v[128:131], v[240:243], v[208:211]
    v_mfma_f32_16x16x32_bf16 v[212:215], v[132:135], v[240:243], v[212:215]
    ds_read_b128 v[240:243], v249 offset:45056
    v_mfma_f32_16x16x32_bf16 v[160:163], v[136:139], v[216:219], v[160:163]
    v_mfma_f32_16x16x32_bf16 v[164:167], v[140:143], v[216:219], v[164:167]
    s_waitcnt lgkmcnt(4)
    v_mfma_f32_16x16x32_bf16 v[168:171], v[136:139], v[220:223], v[168:171]
    v_mfma_f32_16x16x32_bf16 v[172:175], v[140:143], v[220:223], v[172:175]
    s_waitcnt vmcnt(5)
    v_xor_b32 v144, s20, v144
    v_xor_b32 v145, s20, v145
    v_xor_b32 v146, s20, v146
    v_xor_b32 v147, s20, v147
    v_or_b32 v144, v144, v145
    v_or3_b32 v144, v144, v146, v147
    v_cmp_ne_u32 vcc, 0, v144
    s_nop 0
    s_and_b64 vcc, vcc, s[76:77]
    s_mov_b32 s59, 0
    s_cbranch_vccnz .L30_para
.L31_para:
    s_waitcnt lgkmcnt(0)
    s_barrier
    v_mfma_f32_16x16x32_bf16 v[176:179], v[136:139], v[224:227], v[176:179]
    v_add_u32 v250, -94208, v250
    v_add_u32 v248, -94208, v248
    v_add_u32 v249, -94208, v249
    ds_read_b64_tr_b16 v[144:145], v250 offset:0
    v_mfma_f32_16x16x32_bf16 v[180:183], v[140:143], v[224:227], v[180:183]
    ds_read_b64_tr_b16 v[146:147], v250 offset:1024
    s_mov_b32 m0, s66
    s_mov_b32 exec_hi, 0xfff
    buffer_load_dword v255, s[36:39], 0 offen sc1 lds
    s_mov_b32 exec_hi, -1
    v_mfma_f32_16x16x32_bf16 v[184:187], v[136:139], v[228:231], v[184:187]
    ds_read_b64_tr_b16 v[148:149], v250 offset:16384
    v_mfma_f32_16x16x32_bf16 v[188:191], v[140:143], v[228:231], v[188:191]
    ds_read_b64_tr_b16 v[150:151], v250 offset:17408
    v_mfma_f32_16x16x32_bf16 v[192:195], v[136:139], v[232:235], v[192:195]
    ds_read_b128 v[216:219], v248 offset:32768
    v_mfma_f32_16x16x32_bf16 v[196:199], v[140:143], v[232:235], v[196:199]
    ds_read_b128 v[220:223], v248 offset:34816
    s_add_u32 m0, s54, 94208
    s_mov_b32 s64, 123520
    buffer_load_dwordx4 v252, s[24:27], s64 offen lds
    v_mfma_f32_16x16x32_bf16 v[200:203], v[136:139], v[236:239], v[200:203]
    ds_read_b128 v[224:227], v248 offset:36864
    v_mfma_f32_16x16x32_bf16 v[204:207], v[140:143], v[236:239], v[204:207]
    ds_read_b128 v[228:231], v248 offset:38912
    v_mfma_f32_16x16x32_bf16 v[208:211], v[136:139], v[240:243], v[208:211]
    ds_read_b128 v[232:235], v248 offset:40960
    v_mfma_f32_16x16x32_bf16 v[212:215], v[140:143], v[240:243], v[212:215]
    ds_read_b128 v[236:239], v248 offset:43008
    s_add_u32 m0, s54, 102400
    s_mov_b32 s64, 123648
    buffer_load_dwordx4 v252, s[24:27], s64 offen lds
    s_waitcnt lgkmcnt(4)
    v_mfma_f32_16x16x32_bf16 v[160:163], v[144:147], v[216:219], v[160:163]
    ds_read_b128 v[240:243], v248 offset:45056
    v_mfma_f32_16x16x32_bf16 v[164:167], v[148:151], v[216:219], v[164:167]
    ds_read_b64_tr_b16 v[152:153], v250 offset:8192
    v_mfma_f32_16x16x32_bf16 v[168:171], v[144:147], v[220:223], v[168:171]
    ds_read_b64_tr_b16 v[154:155], v250 offset:9216
    v_mfma_f32_16x16x32_bf16 v[172:175], v[148:151], v[220:223], v[172:175]
    ds_read_b64_tr_b16 v[156:157], v250 offset:24576
    s_add_u32 m0, s54, 110592
    s_mov_b32 s64, 123776
    buffer_load_dwordx4 v252, s[24:27], s64 offen lds
    s_waitcnt lgkmcnt(6)
    v_mfma_f32_16x16x32_bf16 v[176:179], v[144:147], v[224:227], v[176:179]
    ds_read_b64_tr_b16 v[158:159], v250 offset:25600
    v_mfma_f32_16x16x32_bf16 v[180:183], v[148:151], v[224:227], v[180:183]
    ds_read_b128 v[216:219], v249 offset:32768
    v_mfma_f32_16x16x32_bf16 v[184:187], v[144:147], v[228:231], v[184:187]
    ds_read_b128 v[220:223], v249 offset:34816
    v_mfma_f32_16x16x32_bf16 v[188:191], v[148:151], v[228:231], v[188:191]
    ds_read_b128 v[224:227], v249 offset:36864
    s_add_u32 m0, s54, 118784
    s_mov_b32 s64, 123904
    buffer_load_dwordx4 v252, s[24:27], s64 offen lds
    s_waitcnt lgkmcnt(8)
    v_mfma_f32_16x16x32_bf16 v[192:195], v[144:147], v[232:235], v[192:195]
    ds_read_b128 v[228:231], v249 offset:38912
    v_mfma_f32_16x16x32_bf16 v[196:199], v[148:151], v[232:235], v[196:199]
    ds_read_b128 v[232:235], v249 offset:40960
    v_mfma_f32_16x16x32_bf16 v[200:203], v[144:147], v[236:239], v[200:203]
    v_mfma_f32_16x16x32_bf16 v[204:207], v[148:151], v[236:239], v[204:207]
    ds_read_b128 v[236:239], v249 offset:43008
    s_add_u32 m0, s54, 126976
    s_mov_b32 s64, 124032
    buffer_load_dwordx4 v252, s[24:27], s64 offen lds
    s_waitcnt lgkmcnt(5)
    v_mfma_f32_16x16x32_bf16 v[208:211], v[144:147], v[240:243], v[208:211]
    v_mfma_f32_16x16x32_bf16 v[212:215], v[148:151], v[240:243], v[212:215]
    ds_read_b128 v[240:243], v249 offset:45056
    v_mfma_f32_16x16x32_bf16 v[160:163], v[152:155], v[216:219], v[160:163]
    v_mfma_f32_16x16x32_bf16 v[164:167], v[156:159], v[216:219], v[164:167]
    s_waitcnt lgkmcnt(4)
    v_mfma_f32_16x16x32_bf16 v[168:171], v[152:155], v[220:223], v[168:171]
    v_mfma_f32_16x16x32_bf16 v[172:175], v[156:159], v[220:223], v[172:175]
    s_waitcnt vmcnt(5) lgkmcnt(0)
    s_barrier
    v_mfma_f32_16x16x32_bf16 v[176:179], v[152:155], v[224:227], v[176:179]
    v_add_u32 v248, 47104, v248
    v_add_u32 v249, 47104, v249
    ds_read_b128 v[216:219], v248 offset:0
    v_mfma_f32_16x16x32_bf16 v[180:183], v[156:159], v[224:227], v[180:183]
    ds_read_b128 v[220:223], v248 offset:2048
    s_add_u32 s64, s0, 125952
    s_add_u32 m0, s74, 0
    s_nop 0
    buffer_load_dwordx4 v247, s[36:39], s64 offen sc1 lds
    v_mfma_f32_16x16x32_bf16 v[184:187], v[152:155], v[228:231], v[184:187]
    ds_read_b128 v[224:227], v249 offset:0
    v_mfma_f32_16x16x32_bf16 v[188:191], v[156:159], v[228:231], v[188:191]
    ds_read_b128 v[228:231], v249 offset:2048
    v_mfma_f32_16x16x32_bf16 v[192:195], v[152:155], v[232:235], v[192:195]
    v_mfma_f32_16x16x32_bf16 v[196:199], v[156:159], v[232:235], v[196:199]
    ds_read_b128 v[232:235], v248 offset:8192
    v_mfma_f32_16x16x32_bf16 v[200:203], v[152:155], v[236:239], v[200:203]
    v_mfma_f32_16x16x32_bf16 v[204:207], v[156:159], v[236:239], v[204:207]
    ds_read_b128 v[236:239], v248 offset:10240
    s_add_u32 s64, s0, 126976
    s_add_u32 m0, s74, 1024
    s_nop 0
    buffer_load_dwordx4 v247, s[36:39], s64 offen sc1 lds
    v_mfma_f32_16x16x32_bf16 v[208:211], v[152:155], v[240:243], v[208:211]
    v_mfma_f32_16x16x32_bf16 v[212:215], v[156:159], v[240:243], v[212:215]
    ds_read_b128 v[240:243], v249 offset:8192
    ds_read_b64 v[250:251], v245 offset:128
    ds_read_b64 v[252:253], v245 offset:256
    s_waitcnt lgkmcnt(1)
    v_fmac_f32_dpp v168, v160, v250 row_newbcast:0 row_mask:0xf bank_mask:0xf
    v_fmac_f32_dpp v169, v161, v250 row_newbcast:0 row_mask:0xf bank_mask:0xf
    v_fmac_f32_dpp v170, v162, v250 row_newbcast:0 row_mask:0xf bank_mask:0xf
    v_fmac_f32_dpp v171, v163, v250 row_newbcast:0 row_mask:0xf bank_mask:0xf
    v_fmac_f32_dpp v172, v164, v250 row_newbcast:0 row_mask:0xf bank_mask:0xf
    v_fmac_f32_dpp v173, v165, v250 row_newbcast:0 row_mask:0xf bank_mask:0xf
    v_fmac_f32_dpp v174, v166, v250 row_newbcast:0 row_mask:0xf bank_mask:0xf
    v_fmac_f32_dpp v175, v167, v250 row_newbcast:0 row_mask:0xf bank_mask:0xf
    v_mul_f32 v251, v251, v251
    s_waitcnt lgkmcnt(0)
    v_fmac_f32_dpp v176, v160, v252 row_newbcast:0 row_mask:0xf bank_mask:0xf
    v_fmac_f32_dpp v177, v161, v252 row_newbcast:0 row_mask:0xf bank_mask:0xf
    v_fmac_f32_dpp v178, v162, v252 row_newbcast:0 row_mask:0xf bank_mask:0xf
    v_fmac_f32_dpp v179, v163, v252 row_newbcast:0 row_mask:0xf bank_mask:0xf
    v_fmac_f32_dpp v180, v164, v252 row_newbcast:0 row_mask:0xf bank_mask:0xf
    v_fmac_f32_dpp v181, v165, v252 row_newbcast:0 row_mask:0xf bank_mask:0xf
    v_fmac_f32_dpp v182, v166, v252 row_newbcast:0 row_mask:0xf bank_mask:0xf
    v_fmac_f32_dpp v183, v167, v252 row_newbcast:0 row_mask:0xf bank_mask:0xf
    v_mul_f32 v253, v253, v253
    v_mul_f32 v168, v168, v172
    v_mul_f32 v169, v169, v173
    v_mul_f32 v170, v170, v174
    v_mul_f32 v171, v171, v175
    v_mul_f32 v168, v168, v251
    v_mul_f32 v169, v169, v251
    v_mul_f32 v170, v170, v251
    v_mul_f32 v171, v171, v251
    v_mul_f32 v176, v176, v180
    v_mul_f32 v177, v177, v181
    v_mul_f32 v178, v178, v182
    v_mul_f32 v179, v179, v183
    v_mul_f32 v176, v176, v253
    v_mul_f32 v177, v177, v253
    v_mul_f32 v178, v178, v253
    v_mul_f32 v179, v179, v253
    v_cvt_pk_bf16_f32 v172, v168, v169
    v_cvt_pk_bf16_f32 v173, v170, v171
    v_cvt_pk_bf16_f32 v174, v176, v177
    v_cvt_pk_bf16_f32 v175, v178, v179
    s_nop 0
    v_permlane32_swap_b32 v172, v174
    v_permlane32_swap_b32 v173, v175
    s_mov_b32 s57, 0
    buffer_store_dwordx4 v[172:175], v244, s[36:39], s57 offen sc1
    s_setprio 3
    v_mfma_f32_16x16x32_bf16 v[168:171], v[0:3], v[216:219], 0
    ds_read_b64 v[250:251], v245 offset:384
    ds_read_b64 v[252:253], v245 offset:512
    s_waitcnt lgkmcnt(1)
    v_fmac_f32_dpp v184, v160, v250 row_newbcast:0 row_mask:0xf bank_mask:0xf
    v_mfma_f32_16x16x32_bf16 v[172:175], v[4:7], v[216:219], 0
    ds_read_b128 v[216:219], v249 offset:10240
    v_fmac_f32_dpp v185, v161, v250 row_newbcast:0 row_mask:0xf bank_mask:0xf
    v_fmac_f32_dpp v186, v162, v250 row_newbcast:0 row_mask:0xf bank_mask:0xf
    v_fmac_f32_dpp v187, v163, v250 row_newbcast:0 row_mask:0xf bank_mask:0xf
    v_mfma_f32_16x16x32_bf16 v[176:179], v[0:3], v[220:223], 0
    v_fmac_f32_dpp v188, v164, v250 row_newbcast:0 row_mask:0xf bank_mask:0xf
    v_fmac_f32_dpp v189, v165, v250 row_newbcast:0 row_mask:0xf bank_mask:0xf
    v_fmac_f32_dpp v190, v166, v250 row_newbcast:0 row_mask:0xf bank_mask:0xf
    v_mfma_f32_16x16x32_bf16 v[180:183], v[4:7], v[220:223], 0
    ds_read_b128 v[220:223], v248 offset:16384
    s_add_u32 s64, s0, 163840
    s_add_u32 m0, s74, 2048
    s_nop 0
    buffer_load_dwordx4 v247, s[36:39], s64 offen sc1 lds
    v_mfma_f32_16x16x32_bf16 v[168:171], v[8:11], v[224:227], v[168:171]
    v_fmac_f32_dpp v191, v167, v250 row_newbcast:0 row_mask:0xf bank_mask:0xf
    v_mul_f32 v251, v251, v251
    s_waitcnt lgkmcnt(2)
    v_fmac_f32_dpp v192, v160, v252 row_newbcast:0 row_mask:0xf bank_mask:0xf
    v_mfma_f32_16x16x32_bf16 v[172:175], v[12:15], v[224:227], v[172:175]
    ds_read_b128 v[224:227], v248 offset:18432
    v_fmac_f32_dpp v193, v161, v252 row_newbcast:0 row_mask:0xf bank_mask:0xf
    v_fmac_f32_dpp v194, v162, v252 row_newbcast:0 row_mask:0xf bank_mask:0xf
    v_fmac_f32_dpp v195, v163, v252 row_newbcast:0 row_mask:0xf bank_mask:0xf
    v_mfma_f32_16x16x32_bf16 v[176:179], v[8:11], v[228:231], v[176:179]
    v_fmac_f32_dpp v196, v164, v252 row_newbcast:0 row_mask:0xf bank_mask:0xf
    v_fmac_f32_dpp v197, v165, v252 row_newbcast:0 row_mask:0xf bank_mask:0xf
    v_fmac_f32_dpp v198, v166, v252 row_newbcast:0 row_mask:0xf bank_mask:0xf
    v_mfma_f32_16x16x32_bf16 v[180:183], v[12:15], v[228:231], v[180:183]
    ds_read_b128 v[228:231], v248 offset:4096
    v_fmac_f32_dpp v199, v167, v252 row_newbcast:0 row_mask:0xf bank_mask:0xf
    v_mul_f32 v253, v253, v253
    v_mul_f32 v184, v184, v188
    v_mfma_f32_16x16x32_bf16 v[168:171], v[16:19], v[232:235], v[168:171]
    v_mul_f32 v185, v185, v189
    v_mul_f32 v186, v186, v190
    v_mul_f32 v187, v187, v191
    v_mfma_f32_16x16x32_bf16 v[172:175], v[20:23], v[232:235], v[172:175]
    ds_read_b128 v[232:235], v248 offset:6144
    s_add_u32 s64, s0, 164864
    s_add_u32 m0, s74, 3072
    s_nop 0
    buffer_load_dwordx4 v247, s[36:39], s64 offen sc1 lds
    v_mfma_f32_16x16x32_bf16 v[176:179], v[16:19], v[236:239], v[176:179]
    v_mul_f32 v184, v184, v251
    v_mul_f32 v185, v185, v251
    v_mul_f32 v186, v186, v251
    v_mfma_f32_16x16x32_bf16 v[180:183], v[20:23], v[236:239], v[180:183]
    ds_read_b128 v[236:239], v249 offset:4096
    v_mul_f32 v187, v187, v251
    v_mul_f32 v192, v192, v196
    v_mul_f32 v193, v193, v197
    s_waitcnt lgkmcnt(5)
    v_mfma_f32_16x16x32_bf16 v[168:171], v[24:27], v[240:243], v[168:171]
    v_mul_f32 v194, v194, v198
    v_mul_f32 v195, v195, v199
    v_mul_f32 v192, v192, v253
    v_mfma_f32_16x16x32_bf16 v[172:175], v[28:31], v[240:243], v[172:175]
    ds_read_b128 v[240:243], v249 offset:6144
    v_mul_f32 v193, v193, v253
    v_mul_f32 v194, v194, v253
    v_mul_f32 v195, v195, v253
    v_mfma_f32_16x16x32_bf16 v[176:179], v[24:27], v[216:219], v[176:179]
    v_cvt_pk_bf16_f32 v188, v184, v185
    v_cvt_pk_bf16_f32 v189, v186, v187
    v_cvt_pk_bf16_f32 v190, v192, v193
    v_mfma_f32_16x16x32_bf16 v[180:183], v[28:31], v[216:219], v[180:183]
    ds_read_b128 v[216:219], v248 offset:12288
    s_add_u32 s64, s0, 165888
    s_add_u32 m0, s74, 4096
    s_nop 0
    buffer_load_dwordx4 v247, s[36:39], s64 offen sc1 lds
    s_waitcnt lgkmcnt(5)
    v_mfma_f32_16x16x32_bf16 v[168:171], v[32:35], v[220:223], v[168:171]
    v_cvt_pk_bf16_f32 v191, v194, v195
    v_permlane32_swap_b32 v188, v190
    s_nop 0
    v_permlane32_swap_b32 v189, v191
    v_mfma_f32_16x16x32_bf16 v[172:175], v[36:39], v[220:223], v[172:175]
    ds_read_b128 v[220:223], v248 offset:14336
    s_mov_b32 s57, 139264
    buffer_store_dwordx4 v[188:191], v244, s[36:39], s57 offen sc1
    v_mfma_f32_16x16x32_bf16 v[176:179], v[32:35], v[224:227], v[176:179]
    v_mfma_f32_16x16x32_bf16 v[180:183], v[36:39], v[224:227], v[180:183]
    ds_read_b128 v[224:227], v249 offset:12288
    s_waitcnt lgkmcnt(5)
    v_mfma_f32_16x16x32_bf16 v[184:187], v[0:3], v[228:231], 0
    ds_read_b64 v[250:251], v245 offset:640
    ds_read_b64 v[252:253], v245 offset:768
    v_mfma_f32_16x16x32_bf16 v[188:191], v[4:7], v[228:231], 0
    ds_read_b128 v[228:231], v249 offset:14336
    s_add_u32 s64, s0, 166912
    s_add_u32 m0, s68, 0
    s_nop 0
    buffer_load_dwordx4 v247, s[36:39], s64 offen sc1 lds
    v_mfma_f32_16x16x32_bf16 v[192:195], v[0:3], v[232:235], 0
    s_waitcnt lgkmcnt(2)
    v_fmac_f32_dpp v200, v160, v250 row_newbcast:0 row_mask:0xf bank_mask:0xf
    v_fmac_f32_dpp v201, v161, v250 row_newbcast:0 row_mask:0xf bank_mask:0xf
    v_mfma_f32_16x16x32_bf16 v[196:199], v[4:7], v[232:235], 0
    ds_read_b128 v[232:235], v248 offset:20480
    v_fmac_f32_dpp v202, v162, v250 row_newbcast:0 row_mask:0xf bank_mask:0xf
    v_fmac_f32_dpp v203, v163, v250 row_newbcast:0 row_mask:0xf bank_mask:0xf
    v_mfma_f32_16x16x32_bf16 v[184:187], v[8:11], v[236:239], v[184:187]
    v_fmac_f32_dpp v204, v164, v250 row_newbcast:0 row_mask:0xf bank_mask:0xf
    v_fmac_f32_dpp v205, v165, v250 row_newbcast:0 row_mask:0xf bank_mask:0xf
    v_mfma_f32_16x16x32_bf16 v[188:191], v[12:15], v[236:239], v[188:191]
    ds_read_b128 v[236:239], v248 offset:22528
    v_fmac_f32_dpp v206, v166, v250 row_newbcast:0 row_mask:0xf bank_mask:0xf
    v_fmac_f32_dpp v207, v167, v250 row_newbcast:0 row_mask:0xf bank_mask:0xf
    v_mfma_f32_16x16x32_bf16 v[192:195], v[8:11], v[240:243], v[192:195]
    v_mul_f32 v251, v251, v251
    s_waitcnt lgkmcnt(3)
    v_fmac_f32_dpp v208, v160, v252 row_newbcast:0 row_mask:0xf bank_mask:0xf
    v_mfma_f32_16x16x32_bf16 v[196:199], v[12:15], v[240:243], v[196:199]
    ds_read_b128 v[240:243], v249 offset:16384
    s_add_u32 s64, s0, 167936
    s_add_u32 m0, s68, 1024
    s_nop 0
    buffer_load_dwordx4 v247, s[36:39], s64 offen sc1 lds
    s_add_u32 s64, s79, 0
    buffer_load_dwordx4 v[0:3], v247, s[36:39], s64 offen offset:0 sc1
    v_mfma_f32_16x16x32_bf16 v[184:187], v[16:19], v[216:219], v[184:187]
    v_fmac_f32_dpp v209, v161, v252 row_newbcast:0 row_mask:0xf bank_mask:0xf
    v_fmac_f32_dpp v210, v162, v252 row_newbcast:0 row_mask:0xf bank_mask:0xf
    v_mfma_f32_16x16x32_bf16 v[188:191], v[20:23], v[216:219], v[188:191]
    ds_read_b128 v[216:219], v249 offset:18432
    v_fmac_f32_dpp v211, v163, v252 row_newbcast:0 row_mask:0xf bank_mask:0xf
    v_fmac_f32_dpp v212, v164, v252 row_newbcast:0 row_mask:0xf bank_mask:0xf
    v_mfma_f32_16x16x32_bf16 v[192:195], v[16:19], v[220:223], v[192:195]
    v_fmac_f32_dpp v213, v165, v252 row_newbcast:0 row_mask:0xf bank_mask:0xf
    v_fmac_f32_dpp v214, v166, v252 row_newbcast:0 row_mask:0xf bank_mask:0xf
    v_mfma_f32_16x16x32_bf16 v[196:199], v[20:23], v[220:223], v[196:199]
    ds_read_b128 v[220:223], v248 offset:24576
    v_fmac_f32_dpp v215, v167, v252 row_newbcast:0 row_mask:0xf bank_mask:0xf
    v_mul_f32 v253, v253, v253
    s_waitcnt lgkmcnt(5)
    v_mfma_f32_16x16x32_bf16 v[184:187], v[24:27], v[224:227], v[184:187]
    v_mul_f32 v200, v200, v204
    v_mul_f32 v201, v201, v205
    v_mfma_f32_16x16x32_bf16 v[188:191], v[28:31], v[224:227], v[188:191]
    ds_read_b128 v[224:227], v248 offset:26624
    v_mul_f32 v202, v202, v206
    v_mul_f32 v203, v203, v207
    s_add_u32 s64, s79, 0
    buffer_load_dwordx4 v[4:7], v247, s[36:39], s64 offen offset:1024 sc1
    v_mfma_f32_16x16x32_bf16 v[192:195], v[24:27], v[228:231], v[192:195]
    v_mul_f32 v200, v200, v251
    v_mul_f32 v201, v201, v251
    v_mfma_f32_16x16x32_bf16 v[196:199], v[28:31], v[228:231], v[196:199]
    ds_read_b128 v[228:231], v249 offset:24576
    v_mul_f32 v202, v202, v251
    v_mul_f32 v203, v203, v251
    s_waitcnt lgkmcnt(5)
    v_mfma_f32_16x16x32_bf16 v[184:187], v[32:35], v[232:235], v[184:187]
    v_mul_f32 v208, v208, v212
    v_mul_f32 v209, v209, v213
    v_mfma_f32_16x16x32_bf16 v[188:191], v[36:39], v[232:235], v[188:191]
    ds_read_b128 v[232:235], v249 offset:26624
    v_mul_f32 v210, v210, v214
    v_mul_f32 v211, v211, v215
    v_mfma_f32_16x16x32_bf16 v[192:195], v[32:35], v[236:239], v[192:195]
    v_mul_f32 v208, v208, v253
    v_mul_f32 v209, v209, v253
    v_mfma_f32_16x16x32_bf16 v[196:199], v[36:39], v[236:239], v[196:199]
    ds_read_b128 v[236:239], v248 offset:32768
    v_mul_f32 v210, v210, v253
    v_mul_f32 v211, v211, v253
    s_add_u32 s64, s79, 0
    buffer_load_dwordx4 v[8:11], v247, s[36:39], s64 offen offset:2048 sc1
    s_waitcnt lgkmcnt(5)
    s_setprio 2
    v_mfma_f32_16x16x32_bf16 v[168:171], v[40:43], v[240:243], v[168:171]
    v_cvt_pk_bf16_f32 v204, v200, v201
    v_cvt_pk_bf16_f32 v205, v202, v203
    v_mfma_f32_16x16x32_bf16 v[172:175], v[44:47], v[240:243], v[172:175]
    ds_read_b128 v[240:243], v248 offset:34816
    v_cvt_pk_bf16_f32 v206, v208, v209
    v_cvt_pk_bf16_f32 v207, v210, v211
    v_mfma_f32_16x16x32_bf16 v[176:179], v[40:43], v[216:219], v[176:179]
    v_permlane32_swap_b32 v204, v206
    v_permlane32_swap_b32 v205, v207
    v_mfma_f32_16x16x32_bf16 v[180:183], v[44:47], v[216:219], v[180:183]
    ds_read_b128 v[216:219], v249 offset:32768
    s_mov_b32 s57, 278528
    buffer_store_dwordx4 v[204:207], v244, s[36:39], s57 offen sc1
    ds_read_b64 v[250:251], v245 offset:0
    s_waitcnt lgkmcnt(6)
    v_mfma_f32_16x16x32_bf16 v[168:171], v[48:51], v[220:223], v[168:171]
    s_waitcnt lgkmcnt(0)
    v_fmac_f32_dpp v160, v160, v250 row_newbcast:0 row_mask:0xf bank_mask:0xf
    v_fmac_f32_dpp v161, v161, v250 row_newbcast:0 row_mask:0xf bank_mask:0xf
    v_mfma_f32_16x16x32_bf16 v[172:175], v[52:55], v[220:223], v[172:175]
    ds_read_b128 v[220:223], v249 offset:34816
    v_fmac_f32_dpp v162, v162, v250 row_newbcast:0 row_mask:0xf bank_mask:0xf
    v_fmac_f32_dpp v163, v163, v250 row_newbcast:0 row_mask:0xf bank_mask:0xf
    s_add_u32 s64, s79, 0
    buffer_load_dwordx4 v[12:15], v247, s[36:39], s64 offen offset:3072 sc1
    v_mfma_f32_16x16x32_bf16 v[176:179], v[48:51], v[224:227], v[176:179]
    v_fmac_f32_dpp v164, v164, v250 row_newbcast:0 row_mask:0xf bank_mask:0xf
    v_fmac_f32_dpp v165, v165, v250 row_newbcast:0 row_mask:0xf bank_mask:0xf
    v_mfma_f32_16x16x32_bf16 v[180:183], v[52:55], v[224:227], v[180:183]
    ds_read_b128 v[224:227], v249 offset:20480
    v_fmac_f32_dpp v166, v166, v250 row_newbcast:0 row_mask:0xf bank_mask:0xf
    v_fmac_f32_dpp v167, v167, v250 row_newbcast:0 row_mask:0xf bank_mask:0xf
    v_mfma_f32_16x16x32_bf16 v[168:171], v[56:59], v[228:231], v[168:171]
    v_mul_f32 v251, v251, v251
    v_mul_f32 v212, v160, v164
    v_mfma_f32_16x16x32_bf16 v[172:175], v[60:63], v[228:231], v[172:175]
    ds_read_b128 v[228:231], v249 offset:22528
    v_mul_f32 v213, v161, v165
    v_mul_f32 v214, v162, v166
    v_mfma_f32_16x16x32_bf16 v[176:179], v[56:59], v[232:235], v[176:179]
    v_mul_f32 v215, v163, v167
    v_mul_f32 v212, v212, v251
    v_mfma_f32_16x16x32_bf16 v[180:183], v[60:63], v[232:235], v[180:183]
    ds_read_b128 v[232:235], v248 offset:28672
    v_mul_f32 v213, v213, v251
    v_mul_f32 v214, v214, v251
    s_add_u32 s64, s79, 4096
    buffer_load_dwordx4 v[16:19], v247, s[36:39], s64 offen offset:0 sc1
    v_mfma_f32_16x16x32_bf16 v[168:171], v[64:67], v[236:239], v[168:171]
    v_mul_f32 v215, v215, v251
    v_cvt_pk_bf16_f32 v208, v212, v213
    v_mfma_f32_16x16x32_bf16 v[172:175], v[68:71], v[236:239], v[172:175]
    ds_read_b128 v[236:239], v248 offset:30720
    v_cvt_pk_bf16_f32 v209, v214, v215
    v_permlane32_swap_b32 v208, v210
    v_mfma_f32_16x16x32_bf16 v[176:179], v[64:67], v[240:243], v[176:179]
    v_permlane32_swap_b32 v209, v211
    buffer_store_dwordx4 v[208:211], v246, s[36:39], 0 offen sc1
    v_mfma_f32_16x16x32_bf16 v[180:183], v[68:71], v[240:243], v[180:183]
    ds_read_b128 v[240:243], v249 offset:28672
    v_mov_b32_dpp v160, v160 row_newbcast:0 row_mask:0xf bank_mask:0xf
    v_mov_b32_dpp v161, v161 row_newbcast:0 row_mask:0xf bank_mask:0xf
    s_waitcnt lgkmcnt(5)
    v_mfma_f32_16x16x32_bf16 v[168:171], v[72:75], v[216:219], v[168:171]
    v_mov_b32_dpp v162, v162 row_newbcast:0 row_mask:0xf bank_mask:0xf
    v_mov_b32_dpp v163, v163 row_newbcast:0 row_mask:0xf bank_mask:0xf
    v_mfma_f32_16x16x32_bf16 v[172:175], v[76:79], v[216:219], v[172:175]
    ds_read_b128 v[216:219], v249 offset:30720
    v_mov_b32_dpp v164, v164 row_newbcast:0 row_mask:0xf bank_mask:0xf
    v_mov_b32_dpp v165, v165 row_newbcast:0 row_mask:0xf bank_mask:0xf
    s_add_u32 s64, s79, 40960
    buffer_load_dwordx4 v[20:23], v247, s[36:39], s64 offen offset:0 sc1
    v_mfma_f32_16x16x32_bf16 v[176:179], v[72:75], v[220:223], v[176:179]
    v_mov_b32_dpp v166, v166 row_newbcast:0 row_mask:0xf bank_mask:0xf
    v_mov_b32_dpp v167, v167 row_newbcast:0 row_mask:0xf bank_mask:0xf
    v_mfma_f32_16x16x32_bf16 v[180:183], v[76:79], v[220:223], v[180:183]
    ds_read_b128 v[220:223], v248 offset:36864
    s_waitcnt lgkmcnt(5)
    v_mfma_f32_16x16x32_bf16 v[184:187], v[40:43], v[224:227], v[184:187]
    v_mfma_f32_16x16x32_bf16 v[188:191], v[44:47], v[224:227], v[188:191]
    ds_read_b128 v[224:227], v248 offset:38912
    v_mfma_f32_16x16x32_bf16 v[192:195], v[40:43], v[228:231], v[192:195]
    v_mfma_f32_16x16x32_bf16 v[196:199], v[44:47], v[228:231], v[196:199]
    ds_read_b128 v[228:231], v249 offset:36864
    s_add_u32 s64, s79, 40960
    buffer_load_dwordx4 v[24:27], v247, s[36:39], s64 offen offset:1024 sc1
    s_waitcnt lgkmcnt(5)
    v_mfma_f32_16x16x32_bf16 v[184:187], v[48:51], v[232:235], v[184:187]
    v_mfma_f32_16x16x32_bf16 v[188:191], v[52:55], v[232:235], v[188:191]
    ds_read_b128 v[232:235], v249 offset:38912
    v_mfma_f32_16x16x32_bf16 v[192:195], v[48:51], v[236:239], v[192:195]
    v_mfma_f32_16x16x32_bf16 v[196:199], v[52:55], v[236:239], v[196:199]
    s_waitcnt lgkmcnt(4)
    v_mfma_f32_16x16x32_bf16 v[184:187], v[56:59], v[240:243], v[184:187]
    v_mfma_f32_16x16x32_bf16 v[188:191], v[60:63], v[240:243], v[188:191]
    s_waitcnt vmcnt(18) lgkmcnt(0)
    s_barrier
    s_add_u32 s64, s79, 40960
    buffer_load_dwordx4 v[28:31], v247, s[36:39], s64 offen offset:2048 sc1
    v_mfma_f32_16x16x32_bf16 v[192:195], v[56:59], v[216:219], v[192:195]
    v_add_u32 v248, 47104, v248
    v_add_u32 v249, 47104, v249
    ds_read_b128 v[236:239], v248 offset:0
    v_mfma_f32_16x16x32_bf16 v[196:199], v[60:63], v[216:219], v[196:199]
    ds_read_b128 v[240:243], v248 offset:2048
    v_mfma_f32_16x16x32_bf16 v[184:187], v[64:67], v[220:223], v[184:187]
    ds_read_b128 v[216:219], v249 offset:0
    v_mfma_f32_16x16x32_bf16 v[188:191], v[68:71], v[220:223], v[188:191]
    ds_read_b128 v[220:223], v249 offset:2048
    v_mfma_f32_16x16x32_bf16 v[192:195], v[64:67], v[224:227], v[192:195]
    v_mfma_f32_16x16x32_bf16 v[196:199], v[68:71], v[224:227], v[196:199]
    ds_read_b128 v[224:227], v248 offset:8192
    s_add_u32 s64, s79, 40960
    buffer_load_dwordx4 v[32:35], v247, s[36:39], s64 offen offset:3072 sc1
    v_mfma_f32_16x16x32_bf16 v[184:187], v[72:75], v[228:231], v[184:187]
    v_mfma_f32_16x16x32_bf16 v[188:191], v[76:79], v[228:231], v[188:191]
    ds_read_b128 v[228:231], v248 offset:10240
    v_mfma_f32_16x16x32_bf16 v[192:195], v[72:75], v[232:235], v[192:195]
    v_mfma_f32_16x16x32_bf16 v[196:199], v[76:79], v[232:235], v[196:199]
    ds_read_b128 v[232:235], v249 offset:8192
    s_waitcnt lgkmcnt(5)
    s_setprio 1
    v_mfma_f32_16x16x32_bf16 v[168:171], v[80:83], v[236:239], v[168:171]
    s_waitcnt vmcnt(4)
    s_nop 0
    v_mfma_f32_16x16x32_bf16 v[172:175], v[84:87], v[236:239], v[172:175]
    ds_read_b128 v[236:239], v249 offset:10240
    v_mov_b32 v202, 163776
    v_mov_b32 v200, 1
    s_mov_b64 exec, 1
    ds_add_rtn_u32 v201, v202, v200 offset:4
    s_mov_b64 exec, -1
    s_add_u32 s64, s79, 45056
    buffer_load_dwordx4 v[36:39], v247, s[36:39], s64 offen offset:0 sc1
    v_mfma_f32_16x16x32_bf16 v[176:179], v[80:83], v[240:243], v[176:179]
    s_nop 0
    v_mfma_f32_16x16x32_bf16 v[180:183], v[84:87], v[240:243], v[180:183]
    ds_read_b128 v[240:243], v248 offset:16384
    s_nop 0
    s_waitcnt lgkmcnt(6)
    v_mfma_f32_16x16x32_bf16 v[168:171], v[88:91], v[216:219], v[168:171]
    s_nop 0
    v_mfma_f32_16x16x32_bf16 v[172:175], v[92:95], v[216:219], v[172:175]
    ds_read_b128 v[216:219], v248 offset:18432
    s_nop 0
    v_mfma_f32_16x16x32_bf16 v[176:179], v[88:91], v[220:223], v[176:179]
    s_waitcnt lgkmcnt(2)
    v_readfirstlane_b32 s56, v201
    v_mov_b32 v200, s20
    s_cmp_lg_u32 s56, 7
    s_cselect_b32 s56, 2130706432, s78
    v_mov_b32 v201, s56
    s_mov_b64 exec, 1
    buffer_store_dword v200, v201, s[36:39], 0 offen sc1
    s_mov_b64 exec, -1
    v_mfma_f32_16x16x32_bf16 v[180:183], v[92:95], v[220:223], v[180:183]
    ds_read_b128 v[220:223], v248 offset:4096
    s_add_u32 s64, s79, 81920
    buffer_load_dwordx4 v[40:43], v247, s[36:39], s64 offen offset:0 sc1
    v_mfma_f32_16x16x32_bf16 v[168:171], v[96:99], v[224:227], v[168:171]
    v_mfma_f32_16x16x32_bf16 v[172:175], v[100:103], v[224:227], v[172:175]
    ds_read_b128 v[224:227], v248 offset:6144
    v_mfma_f32_16x16x32_bf16 v[176:179], v[96:99], v[228:231], v[176:179]
    v_mfma_f32_16x16x32_bf16 v[180:183], v[100:103], v[228:231], v[180:183]
    ds_read_b128 v[228:231], v249 offset:4096
    v_mfma_f32_16x16x32_bf16 v[168:171], v[104:107], v[232:235], v[168:171]
    v_mfma_f32_16x16x32_bf16 v[172:175], v[108:111], v[232:235], v[172:175]
    ds_read_b128 v[232:235], v249 offset:6144
    s_add_u32 s64, s79, 81920
    buffer_load_dwordx4 v[44:47], v247, s[36:39], s64 offen offset:1024 sc1
    v_mfma_f32_16x16x32_bf16 v[176:179], v[104:107], v[236:239], v[176:179]
    v_mfma_f32_16x16x32_bf16 v[180:183], v[108:111], v[236:239], v[180:183]
    ds_read_b128 v[236:239], v248 offset:12288
    s_waitcnt lgkmcnt(5)
    v_mfma_f32_16x16x32_bf16 v[168:171], v[112:115], v[240:243], v[168:171]
    v_mfma_f32_16x16x32_bf16 v[172:175], v[116:119], v[240:243], v[172:175]
    ds_read_b128 v[240:243], v248 offset:14336
    v_mfma_f32_16x16x32_bf16 v[176:179], v[112:115], v[216:219], v[176:179]
    v_mfma_f32_16x16x32_bf16 v[180:183], v[116:119], v[216:219], v[180:183]
    ds_read_b128 v[216:219], v249 offset:12288
    s_add_u32 s64, s79, 81920
    buffer_load_dwordx4 v[48:51], v247, s[36:39], s64 offen offset:2048 sc1
    s_waitcnt lgkmcnt(5)
    v_mfma_f32_16x16x32_bf16 v[184:187], v[80:83], v[220:223], v[184:187]
    v_mfma_f32_16x16x32_bf16 v[188:191], v[84:87], v[220:223], v[188:191]
    ds_read_b128 v[220:223], v249 offset:14336
    v_mfma_f32_16x16x32_bf16 v[192:195], v[80:83], v[224:227], v[192:195]
    v_mfma_f32_16x16x32_bf16 v[196:199], v[84:87], v[224:227], v[196:199]
    ds_read_b128 v[224:227], v248 offset:20480
    s_waitcnt lgkmcnt(5)
    v_mfma_f32_16x16x32_bf16 v[184:187], v[88:91], v[228:231], v[184:187]
    v_mfma_f32_16x16x32_bf16 v[188:191], v[92:95], v[228:231], v[188:191]
    ds_read_b128 v[228:231], v248 offset:22528
    s_add_u32 s64, s79, 81920
    buffer_load_dwordx4 v[52:55], v247, s[36:39], s64 offen offset:3072 sc1
    v_mfma_f32_16x16x32_bf16 v[192:195], v[88:91], v[232:235], v[192:195]
    v_mfma_f32_16x16x32_bf16 v[196:199], v[92:95], v[232:235], v[196:199]
    ds_read_b128 v[232:235], v249 offset:16384
    s_waitcnt lgkmcnt(5)
    v_mfma_f32_16x16x32_bf16 v[184:187], v[96:99], v[236:239], v[184:187]
    v_mfma_f32_16x16x32_bf16 v[188:191], v[100:103], v[236:239], v[188:191]
    ds_read_b128 v[236:239], v249 offset:18432
    v_mfma_f32_16x16x32_bf16 v[192:195], v[96:99], v[240:243], v[192:195]
    v_mfma_f32_16x16x32_bf16 v[196:199], v[100:103], v[240:243], v[196:199]
    ds_read_b128 v[240:243], v248 offset:24576
    s_add_u32 s64, s79, 86016
    buffer_load_dwordx4 v[56:59], v247, s[36:39], s64 offen offset:0 sc1
    s_waitcnt lgkmcnt(5)
    v_mfma_f32_16x16x32_bf16 v[184:187], v[104:107], v[216:219], v[184:187]
    v_mfma_f32_16x16x32_bf16 v[188:191], v[108:111], v[216:219], v[188:191]
    ds_read_b128 v[216:219], v248 offset:26624
    v_mfma_f32_16x16x32_bf16 v[192:195], v[104:107], v[220:223], v[192:195]
    v_mfma_f32_16x16x32_bf16 v[196:199], v[108:111], v[220:223], v[196:199]
    ds_read_b128 v[220:223], v249 offset:24576
    s_waitcnt lgkmcnt(5)
    v_mfma_f32_16x16x32_bf16 v[184:187], v[112:115], v[224:227], v[184:187]
    v_mfma_f32_16x16x32_bf16 v[188:191], v[116:119], v[224:227], v[188:191]
    ds_read_b128 v[224:227], v249 offset:26624
    s_add_u32 s64, s0, 0
    buffer_load_dwordx4 v[60:63], v247, s[36:39], s64 offen offset:0 sc1
    v_mfma_f32_16x16x32_bf16 v[192:195], v[112:115], v[228:231], v[192:195]
    v_mfma_f32_16x16x32_bf16 v[196:199], v[116:119], v[228:231], v[196:199]
    ds_read_b128 v[228:231], v248 offset:32768
    s_waitcnt lgkmcnt(5)
    s_setprio 0
    v_mfma_f32_16x16x32_bf16 v[168:171], v[120:123], v[232:235], v[168:171]
    v_mfma_f32_16x16x32_bf16 v[172:175], v[124:127], v[232:235], v[172:175]
    ds_read_b128 v[232:235], v248 offset:34816
    v_mfma_f32_16x16x32_bf16 v[176:179], v[120:123], v[236:239], v[176:179]
    v_mfma_f32_16x16x32_bf16 v[180:183], v[124:127], v[236:239], v[180:183]
    ds_read_b128 v[236:239], v249 offset:32768
    s_add_u32 s64, s0, 0
    buffer_load_dwordx4 v[64:67], v247, s[36:39], s64 offen offset:1024 sc1
    s_waitcnt lgkmcnt(5)
    v_mfma_f32_16x16x32_bf16 v[168:171], v[128:131], v[240:243], v[168:171]
    v_mfma_f32_16x16x32_bf16 v[172:175], v[132:135], v[240:243], v[172:175]
    ds_read_b128 v[240:243], v249 offset:34816
    v_mfma_f32_16x16x32_bf16 v[176:179], v[128:131], v[216:219], v[176:179]
    v_mfma_f32_16x16x32_bf16 v[180:183], v[132:135], v[216:219], v[180:183]
    ds_read_b128 v[216:219], v249 offset:20480
    s_waitcnt lgkmcnt(5)
    v_mfma_f32_16x16x32_bf16 v[168:171], v[136:139], v[220:223], v[168:171]
    v_mfma_f32_16x16x32_bf16 v[172:175], v[140:143], v[220:223], v[172:175]
    ds_read_b128 v[220:223], v249 offset:22528
    s_add_u32 s64, s0, 0
    buffer_load_dwordx4 v[68:71], v247, s[36:39], s64 offen offset:2048 sc1
    v_mfma_f32_16x16x32_bf16 v[176:179], v[136:139], v[224:227], v[176:179]
    v_mfma_f32_16x16x32_bf16 v[180:183], v[140:143], v[224:227], v[180:183]
    ds_read_b128 v[224:227], v248 offset:28672
    s_waitcnt lgkmcnt(5)
    v_mfma_f32_16x16x32_bf16 v[168:171], v[144:147], v[228:231], v[168:171]
    v_mfma_f32_16x16x32_bf16 v[172:175], v[148:151], v[228:231], v[172:175]
    ds_read_b128 v[228:231], v248 offset:30720
    v_mfma_f32_16x16x32_bf16 v[176:179], v[144:147], v[232:235], v[176:179]
    v_mfma_f32_16x16x32_bf16 v[180:183], v[148:151], v[232:235], v[180:183]
    ds_read_b128 v[232:235], v249 offset:28672
    s_add_u32 s64, s0, 0
    buffer_load_dwordx4 v[72:75], v247, s[36:39], s64 offen offset:3072 sc1
    s_waitcnt lgkmcnt(5)
    v_mfma_f32_16x16x32_bf16 v[168:171], v[152:155], v[236:239], v[168:171]
    v_mfma_f32_16x16x32_bf16 v[172:175], v[156:159], v[236:239], v[172:175]
    ds_read_b128 v[236:239], v249 offset:30720
    v_mfma_f32_16x16x32_bf16 v[176:179], v[152:155], v[240:243], v[176:179]
    v_mfma_f32_16x16x32_bf16 v[180:183], v[156:159], v[240:243], v[180:183]
    ds_read_b128 v[240:243], v248 offset:36864
    s_waitcnt lgkmcnt(5)
    v_mfma_f32_16x16x32_bf16 v[184:187], v[120:123], v[216:219], v[184:187]
    v_mfma_f32_16x16x32_bf16 v[188:191], v[124:127], v[216:219], v[188:191]
    ds_read_b128 v[216:219], v248 offset:38912
    s_add_u32 s64, s0, 4096
    buffer_load_dwordx4 v[76:79], v247, s[36:39], s64 offen offset:0 sc1
    v_mfma_f32_16x16x32_bf16 v[192:195], v[120:123], v[220:223], v[192:195]
    ds_read_b64 v[250:251], v245 offset:896
    ds_read_b64 v[252:253], v245 offset:1024
    s_waitcnt lgkmcnt(1)
    v_fmac_f32 v168, v160, v250
    v_mfma_f32_16x16x32_bf16 v[196:199], v[124:127], v[220:223], v[196:199]
    ds_read_b128 v[220:223], v249 offset:36864
    v_fmac_f32 v169, v161, v250
    v_fmac_f32 v170, v162, v250
    v_fmac_f32 v171, v163, v250
    v_mfma_f32_16x16x32_bf16 v[184:187], v[128:131], v[224:227], v[184:187]
    v_fmac_f32 v172, v164, v250
    v_fmac_f32 v173, v165, v250
    v_fmac_f32 v174, v166, v250
    v_mfma_f32_16x16x32_bf16 v[188:191], v[132:135], v[224:227], v[188:191]
    ds_read_b128 v[224:227], v249 offset:38912
    v_fmac_f32 v175, v167, v250
    v_mul_f32 v251, v251, v251
    s_waitcnt lgkmcnt(2)
    v_fmac_f32 v176, v160, v252
    v_mfma_f32_16x16x32_bf16 v[192:195], v[128:131], v[228:231], v[192:195]
    v_fmac_f32 v177, v161, v252
    v_fmac_f32 v178, v162, v252
    v_fmac_f32 v179, v163, v252
    v_mfma_f32_16x16x32_bf16 v[196:199], v[132:135], v[228:231], v[196:199]
    v_fmac_f32 v180, v164, v252
    v_fmac_f32 v181, v165, v252
    v_fmac_f32 v182, v166, v252
    s_add_u32 s64, s0, 40960
    buffer_load_dwordx4 v[80:83], v247, s[36:39], s64 offen offset:0 sc1
    v_mfma_f32_16x16x32_bf16 v[184:187], v[136:139], v[232:235], v[184:187]
    v_fmac_f32 v183, v167, v252
    v_mul_f32 v253, v253, v253
    v_mul_f32 v168, v168, v172
    v_mfma_f32_16x16x32_bf16 v[188:191], v[140:143], v[232:235], v[188:191]
    v_mul_f32 v169, v169, v173
    v_mul_f32 v170, v170, v174
    v_mul_f32 v171, v171, v175
    v_mfma_f32_16x16x32_bf16 v[192:195], v[136:139], v[236:239], v[192:195]
    v_mul_f32 v168, v168, v251
    v_mul_f32 v169, v169, v251
    v_mul_f32 v170, v170, v251
    v_mfma_f32_16x16x32_bf16 v[196:199], v[140:143], v[236:239], v[196:199]
    v_mul_f32 v171, v171, v251
    v_mul_f32 v176, v176, v180
    v_mul_f32 v177, v177, v181
    v_mfma_f32_16x16x32_bf16 v[184:187], v[144:147], v[240:243], v[184:187]
    v_mul_f32 v178, v178, v182
    v_mul_f32 v179, v179, v183
    v_mul_f32 v176, v176, v253
    v_mfma_f32_16x16x32_bf16 v[188:191], v[148:151], v[240:243], v[188:191]
    v_mul_f32 v177, v177, v253
    v_mul_f32 v178, v178, v253
    v_mul_f32 v179, v179, v253
    s_add_u32 s64, s0, 40960
    buffer_load_dwordx4 v[84:87], v247, s[36:39], s64 offen offset:1024 sc1
    v_mfma_f32_16x16x32_bf16 v[192:195], v[144:147], v[216:219], v[192:195]
    v_cvt_pk_bf16_f32 v172, v168, v169
    v_cvt_pk_bf16_f32 v173, v170, v171
    v_cvt_pk_bf16_f32 v174, v176, v177
    v_mfma_f32_16x16x32_bf16 v[196:199], v[148:151], v[216:219], v[196:199]
    v_cvt_pk_bf16_f32 v175, v178, v179
    v_permlane32_swap_b32 v172, v174
    s_nop 0
    v_permlane32_swap_b32 v173, v175
    s_waitcnt lgkmcnt(1)
    v_mfma_f32_16x16x32_bf16 v[184:187], v[152:155], v[220:223], v[184:187]
    s_mov_b32 s57, 417792
    buffer_store_dwordx4 v[172:175], v244, s[36:39], s57 offen sc1
    v_mfma_f32_16x16x32_bf16 v[188:191], v[156:159], v[220:223], v[188:191]
    s_waitcnt lgkmcnt(0)
    v_mfma_f32_16x16x32_bf16 v[192:195], v[152:155], v[224:227], v[192:195]
    v_mfma_f32_16x16x32_bf16 v[196:199], v[156:159], v[224:227], v[196:199]
    ds_read_b64 v[250:251], v245 offset:1152
    ds_read_b64 v[252:253], v245 offset:1280
    s_waitcnt lgkmcnt(1)
    v_fmac_f32 v184, v160, v250
    v_fmac_f32 v185, v161, v250
    v_fmac_f32 v186, v162, v250
    v_fmac_f32 v187, v163, v250
    v_fmac_f32 v188, v164, v250
    v_fmac_f32 v189, v165, v250
    v_fmac_f32 v190, v166, v250
    v_fmac_f32 v191, v167, v250
    v_mul_f32 v251, v251, v251
    s_waitcnt lgkmcnt(0)
    v_fmac_f32 v192, v160, v252
    v_fmac_f32 v193, v161, v252
    v_fmac_f32 v194, v162, v252
    v_fmac_f32 v195, v163, v252
    v_fmac_f32 v196, v164, v252
    v_fmac_f32 v197, v165, v252
    v_fmac_f32 v198, v166, v252
    v_fmac_f32 v199, v167, v252
    v_mul_f32 v253, v253, v253
    v_mul_f32 v184, v184, v188
    v_mul_f32 v185, v185, v189
    v_mul_f32 v186, v186, v190
    v_mul_f32 v187, v187, v191
    v_mul_f32 v184, v184, v251
    v_mul_f32 v185, v185, v251
    v_mul_f32 v186, v186, v251
    v_mul_f32 v187, v187, v251
    v_mul_f32 v192, v192, v196
    v_mul_f32 v193, v193, v197
    v_mul_f32 v194, v194, v198
    v_mul_f32 v195, v195, v199
    v_mul_f32 v192, v192, v253
    v_mul_f32 v193, v193, v253
    v_mul_f32 v194, v194, v253
    v_mul_f32 v195, v195, v253
    v_cvt_pk_bf16_f32 v188, v184, v185
    v_cvt_pk_bf16_f32 v189, v186, v187
    v_cvt_pk_bf16_f32 v190, v192, v193
    v_cvt_pk_bf16_f32 v191, v194, v195
    s_nop 0
    v_permlane32_swap_b32 v188, v190
    v_permlane32_swap_b32 v189, v191
    s_mov_b32 s57, 557056
    buffer_store_dwordx4 v[188:191], v244, s[36:39], s57 offen sc1
    v_add_u32 v248, s74, v247
    v_add_u32 v244, s68, v247
    ds_read_b128 v[132:135], v248 offset:0
    ds_read_b128 v[136:139], v248 offset:1024
    ds_read_b128 v[140:143], v248 offset:2048
    ds_read_b128 v[144:147], v248 offset:3072
    ds_read_b128 v[148:151], v248 offset:4096
    ds_read_b128 v[152:155], v244 offset:0
    ds_read_b128 v[156:159], v244 offset:1024
    v_mov_b32 v249, v247
    v_mov_b32 v251, 163776
    v_bfe_u32 v216, v254, 2, 3
    v_add_u32 v216, s16, v216
    v_min_u32 v216, s17, v216
    v_and_b32 v217, 3, v254
    v_min_u32 v217, 2, v217
    v_lshlrev_b32 v216, 8, v216
    v_lshl_add_u32 v248, v217, 4, v216
    s_lshl_b32 s15, s49, 13
    s_add_u32 s15, s15, 12599296
    s_cmp_lg_u32 s48, 0
    s_cbranch_scc1 .L33_para
    s_mov_b32 exec_hi, 0
    buffer_load_dwordx4 v[244:247], v248, s[36:39], s15 offen sc1
    s_mov_b32 exec_hi, -1
.L33_para:
    v_mov_b32 v253, 1
    s_mov_b64 exec, 1
    ds_add_u32 v251, v253 offset:28
    s_mov_b64 exec, -1
    v_mul_u32_u24 v218, 4352, v254
    s_mul_i32 s71, s49, 69632
    s_add_u32 s71, s71, 12648448
    s_mul_i32 s69, s53, 8704
    s_add_u32 s69, s69, 3584
    s_lshl_b32 s56, s52, 2
    s_add_u32 s69, s69, s56
    s_add_u32 s69, s69, s71
    s_cmp_ge_u32 s3, 12
    s_cselect_b32 s65, 1, 0
    s_mul_i32 s52, s3, 4352
    s_add_u32 s52, s52, s71
    s_lshl_b32 s14, s14, 8
    s_add_u32 s14, s14, s52
    s_lshl_b32 s21, s21, 8
    s_add_u32 s21, s21, s52
    s_mov_b32 s22, s20
    s_mov_b32 s23, s20
    v_and_b32 v216, 15, v254
    v_lshrrev_b32 v217, 4, v254
    v_mul_u32_u24 v250, 336, v216
    v_lshl_add_u32 v250, v217, 4, v250
    s_and_b32 s68, s48, 3
    s_mul_i32 s56, s68, 21504
    v_add_u32 v250, s56, v250
    s_lshl_b32 s68, s68, 2
    s_add_u32 s56, s68, 163776
    v_mov_b32 v252, s56
    v_mov_b32 v253, 1
    v_mov_b32 v216, s20
    s_mov_b32 s28, s18
    s_and_b32 s29, s19, 0xffff
    s_mov_b32 s30, 2621440
    s_mov_b32 s31, 0x20000
    s_waitcnt vmcnt(0)
    s_mov_b64 exec, 1
    ds_add_rtn_u32 v217, v251, v253
    s_mov_b64 exec, -1
    s_waitcnt lgkmcnt(0)
    v_readfirstlane_b32 s56, v217
    s_nop 0
    s_cmp_lg_u32 s56, 7
    s_cbranch_scc1 .L34_para
    s_mov_b64 exec, 3
    buffer_store_dword v216, v218, s[36:39], s69 offen sc1
    s_mov_b64 exec, -1
.L34_para:
    s_add_u32 s64, s0, 40960
    buffer_load_dwordx4 v[88:91], v249, s[36:39], s64 offen offset:2048 sc1
    s_add_u32 s64, s0, 40960
    buffer_load_dwordx4 v[92:95], v249, s[36:39], s64 offen offset:3072 sc1
    s_add_u32 s64, s0, 45056
    buffer_load_dwordx4 v[96:99], v249, s[36:39], s64 offen offset:0 sc1
    s_add_u32 s64, s0, 81920
    buffer_load_dwordx4 v[100:103], v249, s[36:39], s64 offen offset:0 sc1
    s_add_u32 s64, s0, 81920
    buffer_load_dwordx4 v[104:107], v249, s[36:39], s64 offen offset:1024 sc1
    s_add_u32 s64, s0, 81920
    buffer_load_dwordx4 v[108:111], v249, s[36:39], s64 offen offset:2048 sc1
    s_add_u32 s64, s0, 81920
    buffer_load_dwordx4 v[112:115], v249, s[36:39], s64 offen offset:3072 sc1
    s_add_u32 s64, s0, 86016
    buffer_load_dwordx4 v[116:119], v249, s[36:39], s64 offen offset:0 sc1
    s_add_u32 s64, s0, 122880
    buffer_load_dwordx4 v[120:123], v249, s[36:39], s64 offen offset:0 sc1
    s_add_u32 s64, s0, 122880
    buffer_load_dwordx4 v[124:127], v249, s[36:39], s64 offen offset:1024 sc1
    s_add_u32 s64, s0, 122880
    buffer_load_dwordx4 v[128:131], v249, s[36:39], s64 offen offset:2048 sc1
    s_cmp_ge_u32 s48, 4
    s_cbranch_scc1 .Lp2
    s_add_u32 s64, s0, 204800
    buffer_load_dwordx4 v[160:163], v249, s[36:39], s64 offen offset:0 sc1
    s_add_u32 s64, s0, 204800
    buffer_load_dwordx4 v[164:167], v249, s[36:39], s64 offen offset:1024 sc1
    s_add_u32 s64, s0, 204800
    buffer_load_dwordx4 v[168:171], v249, s[36:39], s64 offen offset:2048 sc1
    s_add_u32 s64, s0, 204800
    buffer_load_dwordx4 v[172:175], v249, s[36:39], s64 offen offset:3072 sc1
    s_add_u32 s64, s0, 208896
    buffer_load_dwordx4 v[176:179], v249, s[36:39], s64 offen offset:0 sc1
    .p2align 6
.Lp2:
    s_cmp_lg_u32 s48, 0
    s_cbranch_scc1 .L37_para
    s_mov_b32 exec_hi, 0
    v_xor_b32 v244, s20, v244
    v_xor_b32 v245, s20, v245
    v_xor_b32 v246, s20, v246
    v_xor_b32 v247, s20, v247
    v_or_b32 v244, v244, v245
    v_or3_b32 v244, v244, v246, v247
    v_cmp_ne_u32 vcc, 0, v244
    s_mov_b32 s59, 0
    s_cbranch_vccnz .L35_para
.L36_para:
    s_mov_b64 exec, 1
    ds_write_b32 v251, v253 offset:20
    s_mov_b64 exec, -1
.L37_para:
    s_mov_b32 s59, 0
.L38_para:
    ds_read_b32 v244, v251 offset:20
    s_add_u32 s59, s59, 1
    s_cmp_lt_u32 s59, 0x100000
    s_cselect_b64 s[62:63], -1, 0
    s_waitcnt lgkmcnt(0)
    v_cmp_ne_u32 vcc, 1, v244
    s_nop 0
    s_and_b64 vcc, vcc, s[62:63]
    s_cbranch_scc1 .L38_para
    buffer_load_dwordx4 v[220:223], v249, s[36:39], s4 offen offset:0 sc1
    buffer_load_dwordx4 v[224:227], v249, s[36:39], s4 offen offset:1024 sc1
    buffer_load_dwordx4 v[228:231], v249, s[36:39], s4 offen offset:2048 sc1
    buffer_load_dwordx4 v[232:235], v249, s[36:39], s1 offen offset:0 sc1
    buffer_load_dwordx4 v[236:239], v249, s[36:39], s1 offen offset:1024 sc1
    buffer_load_dwordx4 v[240:243], v249, s[36:39], s1 offen offset:2048 sc1
    s_cmp_ge_u32 s48, 4
    s_cbranch_scc1 .L39_para
    s_add_u32 s12, s4, 6144
    buffer_load_dwordx4 v[200:203], v249, s[36:39], s12 offen offset:0 sc1
    buffer_load_dwordx4 v[204:207], v249, s[36:39], s12 offen offset:1024 sc1
    buffer_load_dwordx4 v[208:211], v249, s[36:39], s12 offen offset:2048 sc1
.L39_para:
    s_cmp_ge_u32 s48, 4
    s_cbranch_scc1 .Lp2y
.Lp2old:
    s_setprio 2
    s_add_u32 s12, s5, 0
    buffer_load_dwordx4 v[244:247], v249, s[36:39], s12 offen offset:0 sc1
    s_waitcnt vmcnt(9)
    v_mfma_f32_16x16x32_bf16 v[180:183], v[0:3], v[220:223], 0
    v_mfma_f32_16x16x32_bf16 v[184:187], v[4:7], v[220:223], 0
    v_mfma_f32_16x16x32_bf16 v[188:191], v[8:11], v[220:223], 0
    v_mfma_f32_16x16x32_bf16 v[192:195], v[12:15], v[220:223], 0
    v_mfma_f32_16x16x32_bf16 v[196:199], v[16:19], v[220:223], 0
    buffer_load_dwordx4 v[220:223], v249, s[36:39], s12 offen offset:1024 sc1
    s_waitcnt vmcnt(9)
    v_mfma_f32_16x16x32_bf16 v[180:183], v[20:23], v[224:227], v[180:183]
    v_mfma_f32_16x16x32_bf16 v[184:187], v[24:27], v[224:227], v[184:187]
    v_mfma_f32_16x16x32_bf16 v[188:191], v[28:31], v[224:227], v[188:191]
    v_mfma_f32_16x16x32_bf16 v[192:195], v[32:35], v[224:227], v[192:195]
    v_mfma_f32_16x16x32_bf16 v[196:199], v[36:39], v[224:227], v[196:199]
    buffer_load_dwordx4 v[224:227], v249, s[36:39], s12 offen offset:2048 sc1
    s_waitcnt vmcnt(9)
    v_mfma_f32_16x16x32_bf16 v[180:183], v[40:43], v[228:231], v[180:183]
    v_mfma_f32_16x16x32_bf16 v[184:187], v[44:47], v[228:231], v[184:187]
    v_mfma_f32_16x16x32_bf16 v[188:191], v[48:51], v[228:231], v[188:191]
    v_mfma_f32_16x16x32_bf16 v[192:195], v[52:55], v[228:231], v[192:195]
    v_mfma_f32_16x16x32_bf16 v[196:199], v[56:59], v[228:231], v[196:199]
    s_add_u32 s12, s5, 3072
    buffer_load_dwordx4 v[228:231], v249, s[36:39], s12 offen offset:0 sc1
    s_waitcnt vmcnt(9)
    v_mfma_f32_16x16x32_bf16 v[180:183], v[60:63], v[232:235], v[180:183]
    v_mfma_f32_16x16x32_bf16 v[184:187], v[64:67], v[232:235], v[184:187]
    v_mfma_f32_16x16x32_bf16 v[188:191], v[68:71], v[232:235], v[188:191]
    v_mfma_f32_16x16x32_bf16 v[192:195], v[72:75], v[232:235], v[192:195]
    v_mfma_f32_16x16x32_bf16 v[196:199], v[76:79], v[232:235], v[196:199]
    buffer_load_dwordx4 v[232:235], v249, s[36:39], s12 offen offset:1024 sc1
    s_waitcnt vmcnt(9)
    v_mfma_f32_16x16x32_bf16 v[180:183], v[80:83], v[236:239], v[180:183]
    v_mfma_f32_16x16x32_bf16 v[184:187], v[84:87], v[236:239], v[184:187]
    v_mfma_f32_16x16x32_bf16 v[188:191], v[88:91], v[236:239], v[188:191]
    v_mfma_f32_16x16x32_bf16 v[192:195], v[92:95], v[236:239], v[192:195]
    v_mfma_f32_16x16x32_bf16 v[196:199], v[96:99], v[236:239], v[196:199]
    buffer_load_dwordx4 v[236:239], v249, s[36:39], s12 offen offset:2048 sc1
    s_waitcnt vmcnt(9)
    v_mfma_f32_16x16x32_bf16 v[180:183], v[100:103], v[240:243], v[180:183]
    v_mfma_f32_16x16x32_bf16 v[184:187], v[104:107], v[240:243], v[184:187]
    v_mfma_f32_16x16x32_bf16 v[188:191], v[108:111], v[240:243], v[188:191]
    v_mfma_f32_16x16x32_bf16 v[192:195], v[112:115], v[240:243], v[192:195]
    v_mfma_f32_16x16x32_bf16 v[196:199], v[116:119], v[240:243], v[196:199]
    s_add_u32 s12, s5, 6144
    buffer_load_dwordx4 v[240:243], v249, s[36:39], s12 offen offset:0 sc1
    s_waitcnt vmcnt(9)
    v_mfma_f32_16x16x32_bf16 v[180:183], v[120:123], v[200:203], v[180:183]
    ds_read_b32 v255, v251 offset:28
    v_mfma_f32_16x16x32_bf16 v[184:187], v[124:127], v[200:203], v[184:187]
    v_mfma_f32_16x16x32_bf16 v[188:191], v[128:131], v[200:203], v[188:191]
    v_mfma_f32_16x16x32_bf16 v[192:195], v[132:135], v[200:203], v[192:195]
    v_mfma_f32_16x16x32_bf16 v[196:199], v[136:139], v[200:203], v[196:199]
    buffer_load_dwordx4 v[200:203], v249, s[36:39], s12 offen offset:1024 sc1
    s_waitcnt vmcnt(9)
    v_mfma_f32_16x16x32_bf16 v[180:183], v[140:143], v[204:207], v[180:183]
    v_mfma_f32_16x16x32_bf16 v[184:187], v[144:147], v[204:207], v[184:187]
    v_mfma_f32_16x16x32_bf16 v[188:191], v[148:151], v[204:207], v[188:191]
    v_mfma_f32_16x16x32_bf16 v[192:195], v[152:155], v[204:207], v[192:195]
    v_mfma_f32_16x16x32_bf16 v[196:199], v[156:159], v[204:207], v[196:199]
    buffer_load_dwordx4 v[204:207], v249, s[36:39], s12 offen offset:2048 sc1
    s_waitcnt vmcnt(9)
    v_mfma_f32_16x16x32_bf16 v[180:183], v[160:163], v[208:211], v[180:183]
    s_waitcnt lgkmcnt(0)
    v_cmp_ne_u32 vcc, 8, v255
    s_mov_b32 s59, 0
    s_cbranch_vccnz .L40_para
.L41_para:
    v_mfma_f32_16x16x32_bf16 v[184:187], v[164:167], v[208:211], v[184:187]
    v_mfma_f32_16x16x32_bf16 v[188:191], v[168:171], v[208:211], v[188:191]
    v_mfma_f32_16x16x32_bf16 v[192:195], v[172:175], v[208:211], v[192:195]
    v_mfma_f32_16x16x32_bf16 v[196:199], v[176:179], v[208:211], v[196:199]
    s_waitcnt vmcnt(8)
    v_mfma_f32_16x16x32_bf16 v[212:215], v[0:3], v[244:247], 0
    ds_write_b128 v250, v[180:183] offset:0
    v_mfma_f32_16x16x32_bf16 v[216:219], v[4:7], v[244:247], 0
    s_nop 0
    ds_write_b128 v250, v[184:187] offset:64
    v_mfma_f32_16x16x32_bf16 v[180:183], v[8:11], v[244:247], 0
    ds_write_b128 v250, v[188:191] offset:128
    v_mfma_f32_16x16x32_bf16 v[184:187], v[12:15], v[244:247], 0
    v_mfma_f32_16x16x32_bf16 v[188:191], v[16:19], v[244:247], 0
    s_waitcnt vmcnt(7)
    v_mfma_f32_16x16x32_bf16 v[212:215], v[20:23], v[220:223], v[212:215]
    v_mfma_f32_16x16x32_bf16 v[216:219], v[24:27], v[220:223], v[216:219]
    v_mfma_f32_16x16x32_bf16 v[180:183], v[28:31], v[220:223], v[180:183]
    v_mfma_f32_16x16x32_bf16 v[184:187], v[32:35], v[220:223], v[184:187]
    ds_write_b128 v250, v[192:195] offset:192
    v_mfma_f32_16x16x32_bf16 v[188:191], v[36:39], v[220:223], v[188:191]
    s_waitcnt vmcnt(6)
    v_mfma_f32_16x16x32_bf16 v[212:215], v[40:43], v[224:227], v[212:215]
    v_mfma_f32_16x16x32_bf16 v[216:219], v[44:47], v[224:227], v[216:219]
    v_mfma_f32_16x16x32_bf16 v[180:183], v[48:51], v[224:227], v[180:183]
    v_mfma_f32_16x16x32_bf16 v[184:187], v[52:55], v[224:227], v[184:187]
    v_mfma_f32_16x16x32_bf16 v[188:191], v[56:59], v[224:227], v[188:191]
    ds_write_b128 v250, v[196:199] offset:256
    s_waitcnt vmcnt(5)
    v_mfma_f32_16x16x32_bf16 v[212:215], v[60:63], v[228:231], v[212:215]
    v_mfma_f32_16x16x32_bf16 v[216:219], v[64:67], v[228:231], v[216:219]
    v_mfma_f32_16x16x32_bf16 v[180:183], v[68:71], v[228:231], v[180:183]
    v_mfma_f32_16x16x32_bf16 v[184:187], v[72:75], v[228:231], v[184:187]
    v_mfma_f32_16x16x32_bf16 v[188:191], v[76:79], v[228:231], v[188:191]
    ds_read_b32 v254, v251 offset:8
    s_waitcnt vmcnt(4)
    v_mfma_f32_16x16x32_bf16 v[212:215], v[80:83], v[232:235], v[212:215]
    v_mfma_f32_16x16x32_bf16 v[216:219], v[84:87], v[232:235], v[216:219]
    v_mfma_f32_16x16x32_bf16 v[180:183], v[88:91], v[232:235], v[180:183]
    v_mfma_f32_16x16x32_bf16 v[184:187], v[92:95], v[232:235], v[184:187]
    v_mfma_f32_16x16x32_bf16 v[188:191], v[96:99], v[232:235], v[188:191]
    s_waitcnt lgkmcnt(0)
    v_or_b32 v254, s65, v254
    v_cmp_ne_u32 vcc, 1, v254
    s_mov_b32 s59, 0
    s_cbranch_vccnz .L43_para
.L44_para:
    s_add_u32 s12, s6, 0
    buffer_load_dwordx4 v[208:211], v249, s[36:39], s12 offen offset:0 sc1
    buffer_load_dwordx4 v[244:247], v249, s[36:39], s12 offen offset:1024 sc1
    s_waitcnt vmcnt(5)
    v_mfma_f32_16x16x32_bf16 v[212:215], v[100:103], v[236:239], v[212:215]
    v_mfma_f32_16x16x32_bf16 v[216:219], v[104:107], v[236:239], v[216:219]
    v_mfma_f32_16x16x32_bf16 v[180:183], v[108:111], v[236:239], v[180:183]
    v_mfma_f32_16x16x32_bf16 v[184:187], v[112:115], v[236:239], v[184:187]
    v_mfma_f32_16x16x32_bf16 v[188:191], v[116:119], v[236:239], v[188:191]
    buffer_load_dwordx4 v[220:223], v249, s[36:39], s12 offen offset:2048 sc1
    s_add_u32 s12, s6, 3072
    buffer_load_dwordx4 v[224:227], v249, s[36:39], s12 offen offset:0 sc1
    s_waitcnt vmcnt(6)
    v_mfma_f32_16x16x32_bf16 v[212:215], v[120:123], v[240:243], v[212:215]
    v_mfma_f32_16x16x32_bf16 v[216:219], v[124:127], v[240:243], v[216:219]
    v_mfma_f32_16x16x32_bf16 v[180:183], v[128:131], v[240:243], v[180:183]
    v_mfma_f32_16x16x32_bf16 v[184:187], v[132:135], v[240:243], v[184:187]
    v_mfma_f32_16x16x32_bf16 v[188:191], v[136:139], v[240:243], v[188:191]
    buffer_load_dwordx4 v[228:231], v249, s[36:39], s12 offen offset:1024 sc1
    buffer_load_dwordx4 v[232:235], v249, s[36:39], s12 offen offset:2048 sc1
    s_waitcnt vmcnt(7)
    v_mfma_f32_16x16x32_bf16 v[212:215], v[140:143], v[200:203], v[212:215]
    v_mfma_f32_16x16x32_bf16 v[216:219], v[144:147], v[200:203], v[216:219]
    v_mfma_f32_16x16x32_bf16 v[180:183], v[148:151], v[200:203], v[180:183]
    v_mfma_f32_16x16x32_bf16 v[184:187], v[152:155], v[200:203], v[184:187]
    v_mfma_f32_16x16x32_bf16 v[188:191], v[156:159], v[200:203], v[188:191]
    s_add_u32 s12, s6, 6144
    buffer_load_dwordx4 v[236:239], v249, s[36:39], s12 offen offset:0 sc1
    buffer_load_dwordx4 v[240:243], v249, s[36:39], s12 offen offset:1024 sc1
    s_waitcnt vmcnt(8)
    v_mfma_f32_16x16x32_bf16 v[212:215], v[160:163], v[204:207], v[212:215]
    v_mfma_f32_16x16x32_bf16 v[216:219], v[164:167], v[204:207], v[216:219]
    v_mfma_f32_16x16x32_bf16 v[180:183], v[168:171], v[204:207], v[180:183]
    v_mfma_f32_16x16x32_bf16 v[184:187], v[172:175], v[204:207], v[184:187]
    v_mfma_f32_16x16x32_bf16 v[188:191], v[176:179], v[204:207], v[188:191]
    buffer_load_dwordx4 v[200:203], v249, s[36:39], s12 offen offset:2048 sc1
    s_add_u32 s12, s7, 0
    buffer_load_dwordx4 v[204:207], v249, s[36:39], s12 offen offset:0 sc1
    s_waitcnt vmcnt(9)
    v_mfma_f32_16x16x32_bf16 v[192:195], v[0:3], v[208:211], 0
    ds_write_b128 v250, v[212:215] offset:5376
    v_mfma_f32_16x16x32_bf16 v[196:199], v[4:7], v[208:211], 0
    ds_write_b128 v250, v[216:219] offset:5440
    v_mfma_f32_16x16x32_bf16 v[212:215], v[8:11], v[208:211], 0
    ds_write_b128 v250, v[180:183] offset:5504
    v_mfma_f32_16x16x32_bf16 v[216:219], v[12:15], v[208:211], 0
    v_mfma_f32_16x16x32_bf16 v[180:183], v[16:19], v[208:211], 0
    buffer_load_dwordx4 v[208:211], v249, s[36:39], s12 offen offset:1024 sc1
    s_waitcnt vmcnt(9)
    v_mfma_f32_16x16x32_bf16 v[192:195], v[20:23], v[244:247], v[192:195]
    v_mul_u32_u24 v254, 26, v249
    v_mfma_f32_16x16x32_bf16 v[196:199], v[24:27], v[244:247], v[196:199]
    v_lshrrev_b32 v254, 12, v254
    v_mfma_f32_16x16x32_bf16 v[212:215], v[28:31], v[244:247], v[212:215]
    v_mul_u32_u24 v248, 2400, v254
    v_mfma_f32_16x16x32_bf16 v[216:219], v[32:35], v[244:247], v[216:219]
    ds_write_b128 v250, v[184:187] offset:5568
    v_mfma_f32_16x16x32_bf16 v[180:183], v[36:39], v[244:247], v[180:183]
    s_mul_i32 s56, s68, 2560
    v_add3_u32 v248, v248, v249, s56
    buffer_load_dwordx4 v[244:247], v249, s[36:39], s12 offen offset:2048 sc1
    s_waitcnt vmcnt(9)
    v_mfma_f32_16x16x32_bf16 v[192:195], v[40:43], v[220:223], v[192:195]
    s_mul_i32 s57, s68, 640
    s_add_u32 m0, s57, 150528
    s_mov_b32 exec_hi, 0xff
    buffer_load_dwordx4 v248, s[24:27], s8 offen lds
    s_mov_b32 exec_hi, -1
    v_mfma_f32_16x16x32_bf16 v[196:199], v[44:47], v[220:223], v[196:199]
    s_mul_i32 s57, s68, 640
    s_add_u32 m0, s57, 151168
    s_mov_b32 exec_hi, 0xff
    buffer_load_dwordx4 v248, s[24:27], s9 offen lds
    s_mov_b32 exec_hi, -1
    v_mfma_f32_16x16x32_bf16 v[212:215], v[48:51], v[220:223], v[212:215]
    s_mul_i32 s57, s68, 640
    s_add_u32 m0, s57, 151808
    s_mov_b32 exec_hi, 0xff
    buffer_load_dwordx4 v248, s[24:27], s10 offen lds
    s_mov_b32 exec_hi, -1
    v_mfma_f32_16x16x32_bf16 v[216:219], v[52:55], v[220:223], v[216:219]
    s_mul_i32 s57, s68, 640
    s_add_u32 m0, s57, 152448
    s_mov_b32 exec_hi, 0xff
    buffer_load_dwordx4 v248, s[24:27], s11 offen lds
    s_mov_b32 exec_hi, -1
    v_mfma_f32_16x16x32_bf16 v[180:183], v[56:59], v[220:223], v[180:183]
    ds_write_b128 v250, v[188:191] offset:5632
    s_add_u32 s12, s7, 3072
    buffer_load_dwordx4 v[220:223], v249, s[36:39], s12 offen offset:0 sc1
    s_waitcnt vmcnt(13)
    v_mfma_f32_16x16x32_bf16 v[192:195], v[60:63], v[224:227], v[192:195]
    s_mov_b64 exec, 1
    ds_add_u32 v251, v253 offset:24
    s_mov_b64 exec, -1
    v_mfma_f32_16x16x32_bf16 v[196:199], v[64:67], v[224:227], v[196:199]
    v_mfma_f32_16x16x32_bf16 v[212:215], v[68:71], v[224:227], v[212:215]
    v_mfma_f32_16x16x32_bf16 v[216:219], v[72:75], v[224:227], v[216:219]
    v_mfma_f32_16x16x32_bf16 v[180:183], v[76:79], v[224:227], v[180:183]
    buffer_load_dwordx4 v[224:227], v249, s[36:39], s12 offen offset:1024 sc1
    s_waitcnt vmcnt(13)
    v_mfma_f32_16x16x32_bf16 v[192:195], v[80:83], v[228:231], v[192:195]
    v_mfma_f32_16x16x32_bf16 v[196:199], v[84:87], v[228:231], v[196:199]
    v_mfma_f32_16x16x32_bf16 v[212:215], v[88:91], v[228:231], v[212:215]
    v_mfma_f32_16x16x32_bf16 v[216:219], v[92:95], v[228:231], v[216:219]
    v_mfma_f32_16x16x32_bf16 v[180:183], v[96:99], v[228:231], v[180:183]
    buffer_load_dwordx4 v[228:231], v249, s[36:39], s12 offen offset:2048 sc1
    s_waitcnt vmcnt(13)
    v_mfma_f32_16x16x32_bf16 v[192:195], v[100:103], v[232:235], v[192:195]
    v_mfma_f32_16x16x32_bf16 v[196:199], v[104:107], v[232:235], v[196:199]
    v_mfma_f32_16x16x32_bf16 v[212:215], v[108:111], v[232:235], v[212:215]
    v_mfma_f32_16x16x32_bf16 v[216:219], v[112:115], v[232:235], v[216:219]
    v_mfma_f32_16x16x32_bf16 v[180:183], v[116:119], v[232:235], v[180:183]
    s_add_u32 s12, s7, 6144
    buffer_load_dwordx4 v[232:235], v249, s[36:39], s12 offen offset:0 sc1
    s_waitcnt vmcnt(13)
    v_mfma_f32_16x16x32_bf16 v[192:195], v[120:123], v[236:239], v[192:195]
    v_mfma_f32_16x16x32_bf16 v[196:199], v[124:127], v[236:239], v[196:199]
    v_mfma_f32_16x16x32_bf16 v[212:215], v[128:131], v[236:239], v[212:215]
    v_mfma_f32_16x16x32_bf16 v[216:219], v[132:135], v[236:239], v[216:219]
    v_mfma_f32_16x16x32_bf16 v[180:183], v[136:139], v[236:239], v[180:183]
    buffer_load_dwordx4 v[236:239], v249, s[36:39], s12 offen offset:1024 sc1
    s_waitcnt vmcnt(13)
    v_mfma_f32_16x16x32_bf16 v[192:195], v[140:143], v[240:243], v[192:195]
    v_mfma_f32_16x16x32_bf16 v[196:199], v[144:147], v[240:243], v[196:199]
    v_mfma_f32_16x16x32_bf16 v[212:215], v[148:151], v[240:243], v[212:215]
    v_mfma_f32_16x16x32_bf16 v[216:219], v[152:155], v[240:243], v[216:219]
    v_mfma_f32_16x16x32_bf16 v[180:183], v[156:159], v[240:243], v[180:183]
    buffer_load_dwordx4 v[240:243], v249, s[36:39], s12 offen offset:2048 sc1
    s_waitcnt vmcnt(13)
    v_mfma_f32_16x16x32_bf16 v[192:195], v[160:163], v[200:203], v[192:195]
    v_mfma_f32_16x16x32_bf16 v[196:199], v[164:167], v[200:203], v[196:199]
    v_mfma_f32_16x16x32_bf16 v[212:215], v[168:171], v[200:203], v[212:215]
    v_mfma_f32_16x16x32_bf16 v[216:219], v[172:175], v[200:203], v[216:219]
    v_mfma_f32_16x16x32_bf16 v[180:183], v[176:179], v[200:203], v[180:183]
    s_waitcnt vmcnt(12)
    v_mfma_f32_16x16x32_bf16 v[184:187], v[0:3], v[204:207], 0
    s_nop 1
    ds_write_b128 v250, v[192:195] offset:10752
    v_mfma_f32_16x16x32_bf16 v[188:191], v[4:7], v[204:207], 0
    ds_write_b128 v250, v[196:199] offset:10816
    v_mfma_f32_16x16x32_bf16 v[192:195], v[8:11], v[204:207], 0
    ds_write_b128 v250, v[212:215] offset:10880
    v_mfma_f32_16x16x32_bf16 v[196:199], v[12:15], v[204:207], 0
    v_mfma_f32_16x16x32_bf16 v[212:215], v[16:19], v[204:207], 0
    s_waitcnt vmcnt(11)
    v_mfma_f32_16x16x32_bf16 v[184:187], v[20:23], v[208:211], v[184:187]
    v_mul_u32_u24 v1, 16, v254
    v_mfma_f32_16x16x32_bf16 v[188:191], v[24:27], v[208:211], v[188:191]
    v_lshl_add_u32 v1, v249, 1, v1
    v_mfma_f32_16x16x32_bf16 v[192:195], v[28:31], v[208:211], v[192:195]
    s_mul_i32 s56, s68, 336
    v_add_u32 v1, s56, v1
    v_mfma_f32_16x16x32_bf16 v[196:199], v[32:35], v[208:211], v[196:199]
    ds_write_b128 v250, v[216:219] offset:10944
    v_mfma_f32_16x16x32_bf16 v[212:215], v[36:39], v[208:211], v[212:215]
    v_add_u32 v2, 43008, v1
    s_waitcnt vmcnt(10)
    v_mfma_f32_16x16x32_bf16 v[184:187], v[40:43], v[244:247], v[184:187]
    v_add_u32 v3, 86016, v1
    v_mfma_f32_16x16x32_bf16 v[188:191], v[44:47], v[244:247], v[188:191]
    s_add_u32 s57, s57, 150528
    v_add_u32 v0, s57, v249
    v_mfma_f32_16x16x32_bf16 v[192:195], v[48:51], v[244:247], v[192:195]
    v_mfma_f32_16x16x32_bf16 v[196:199], v[52:55], v[244:247], v[196:199]
    v_mfma_f32_16x16x32_bf16 v[212:215], v[56:59], v[244:247], v[212:215]
    ds_write_b128 v250, v[180:183] offset:11008
    s_waitcnt vmcnt(5)
    v_mfma_f32_16x16x32_bf16 v[184:187], v[60:63], v[220:223], v[184:187]
    v_mov_b32 v255, 2
    ds_write_b32 v252, v255 offset:32
    v_mfma_f32_16x16x32_bf16 v[188:191], v[64:67], v[220:223], v[188:191]
    v_mfma_f32_16x16x32_bf16 v[192:195], v[68:71], v[220:223], v[192:195]
    v_mfma_f32_16x16x32_bf16 v[196:199], v[72:75], v[220:223], v[196:199]
    v_mfma_f32_16x16x32_bf16 v[212:215], v[76:79], v[220:223], v[212:215]
    s_waitcnt vmcnt(4)
    v_mfma_f32_16x16x32_bf16 v[184:187], v[80:83], v[224:227], v[184:187]
    v_mfma_f32_16x16x32_bf16 v[188:191], v[84:87], v[224:227], v[188:191]
    v_mfma_f32_16x16x32_bf16 v[192:195], v[88:91], v[224:227], v[192:195]
    v_mfma_f32_16x16x32_bf16 v[196:199], v[92:95], v[224:227], v[196:199]
    v_mfma_f32_16x16x32_bf16 v[212:215], v[96:99], v[224:227], v[212:215]
    s_waitcnt vmcnt(3)
    v_mfma_f32_16x16x32_bf16 v[184:187], v[100:103], v[228:231], v[184:187]
    v_mfma_f32_16x16x32_bf16 v[188:191], v[104:107], v[228:231], v[188:191]
    v_mfma_f32_16x16x32_bf16 v[192:195], v[108:111], v[228:231], v[192:195]
    v_mfma_f32_16x16x32_bf16 v[196:199], v[112:115], v[228:231], v[196:199]
    v_mfma_f32_16x16x32_bf16 v[212:215], v[116:119], v[228:231], v[212:215]
    s_waitcnt vmcnt(2)
    v_mfma_f32_16x16x32_bf16 v[184:187], v[120:123], v[232:235], v[184:187]
    v_mfma_f32_16x16x32_bf16 v[188:191], v[124:127], v[232:235], v[188:191]
    v_mfma_f32_16x16x32_bf16 v[192:195], v[128:131], v[232:235], v[192:195]
    v_mfma_f32_16x16x32_bf16 v[196:199], v[132:135], v[232:235], v[196:199]
    v_mfma_f32_16x16x32_bf16 v[212:215], v[136:139], v[232:235], v[212:215]
    s_waitcnt vmcnt(1)
    v_mfma_f32_16x16x32_bf16 v[184:187], v[140:143], v[236:239], v[184:187]
    v_mfma_f32_16x16x32_bf16 v[188:191], v[144:147], v[236:239], v[188:191]
    v_mfma_f32_16x16x32_bf16 v[192:195], v[148:151], v[236:239], v[192:195]
    v_mfma_f32_16x16x32_bf16 v[196:199], v[152:155], v[236:239], v[196:199]
    v_mfma_f32_16x16x32_bf16 v[212:215], v[156:159], v[236:239], v[212:215]
    s_waitcnt vmcnt(0)
    v_mfma_f32_16x16x32_bf16 v[184:187], v[160:163], v[240:243], v[184:187]
    v_mfma_f32_16x16x32_bf16 v[188:191], v[164:167], v[240:243], v[188:191]
    v_mfma_f32_16x16x32_bf16 v[192:195], v[168:171], v[240:243], v[192:195]
    v_mfma_f32_16x16x32_bf16 v[196:199], v[172:175], v[240:243], v[196:199]
    v_mfma_f32_16x16x32_bf16 v[212:215], v[176:179], v[240:243], v[212:215]
    s_nop 3
    ds_write_b128 v250, v[184:187] offset:16128
    ds_write_b128 v250, v[188:191] offset:16192
    ds_write_b128 v250, v[192:195] offset:16256
    ds_write_b128 v250, v[196:199] offset:16320
    ds_write_b128 v250, v[212:215] offset:16384
    v_mov_b32 v255, 3
    ds_write_b32 v252, v255 offset:32
    s_setprio 2
    s_mov_b32 exec_hi, 0xff
    ds_read_b128 v[4:7], v0 offset:0
    ds_read_b128 v[8:11], v0 offset:640
    ds_read_b128 v[12:15], v0 offset:1280
    ds_read_b128 v[16:19], v0 offset:1920
    s_mov_b32 s59, 0
.L46_para:
    ds_read_b32 v255, v251 offset:24
    s_add_u32 s59, s59, 1
    s_cmp_lt_u32 s59, 0x100000
    s_cselect_b64 s[62:63], -1, 0
    s_waitcnt lgkmcnt(0)
    v_cmp_ne_u32 vcc, 4, v255
    s_nop 0
    s_and_b64 vcc, vcc, s[62:63]
    s_cbranch_scc1 .L46_para
    ds_read_b128 v[20:23], v1 offset:0
    ds_read_b128 v[24:27], v1 offset:16
    ds_read_b128 v[28:31], v1 offset:21504
    ds_read_b128 v[32:35], v1 offset:21520
    ds_read_b128 v[36:39], v2 offset:0
    ds_read_b128 v[40:43], v2 offset:16
    ds_read_b128 v[44:47], v2 offset:21504
    ds_read_b128 v[48:51], v2 offset:21520
    ds_read_b128 v[52:55], v1 offset:5376
    ds_read_b128 v[56:59], v1 offset:5392
    ds_read_b128 v[60:63], v1 offset:26880
    ds_read_b128 v[64:67], v1 offset:26896
    ds_read_b128 v[68:71], v2 offset:5376
    ds_read_b128 v[72:75], v2 offset:5392
    ds_read_b128 v[76:79], v2 offset:26880
    ds_read_b128 v[80:83], v2 offset:26896
    v_lshlrev_b32 v120, 16, v4
    v_and_b32 v121, 0xffff0000, v4
    v_lshlrev_b32 v122, 16, v5
    v_and_b32 v123, 0xffff0000, v5
    v_lshlrev_b32 v124, 16, v6
    v_and_b32 v125, 0xffff0000, v6
    v_lshlrev_b32 v126, 16, v7
    v_and_b32 v127, 0xffff0000, v7
    s_waitcnt lgkmcnt(12)
    v_add_f32 v120, v120, v20
    v_add_f32 v121, v121, v21
    v_add_f32 v122, v122, v22
    v_add_f32 v123, v123, v23
    v_add_f32 v124, v124, v24
    v_add_f32 v125, v125, v25
    v_add_f32 v126, v126, v26
    v_add_f32 v127, v127, v27
    s_waitcnt lgkmcnt(10)
    v_add_f32 v28, v28, v36
    v_add_f32 v29, v29, v37
    v_add_f32 v30, v30, v38
    v_add_f32 v31, v31, v39
    v_add_f32 v32, v32, v40
    v_add_f32 v33, v33, v41
    v_add_f32 v34, v34, v42
    v_add_f32 v35, v35, v43
    s_waitcnt lgkmcnt(8)
    v_add_f32 v120, v120, v44
    v_add_f32 v121, v121, v45
    v_add_f32 v122, v122, v46
    v_add_f32 v123, v123, v47
    v_add_f32 v124, v124, v48
    v_add_f32 v125, v125, v49
    v_add_f32 v126, v126, v50
    v_add_f32 v127, v127, v51
    v_add_f32 v120, v120, v28
    v_add_f32 v121, v121, v29
    v_add_f32 v122, v122, v30
    v_add_f32 v123, v123, v31
    v_add_f32 v124, v124, v32
    v_add_f32 v125, v125, v33
    v_add_f32 v126, v126, v34
    v_add_f32 v127, v127, v35
    v_lshlrev_b32 v128, 16, v8
    v_and_b32 v129, 0xffff0000, v8
    v_lshlrev_b32 v130, 16, v9
    v_and_b32 v131, 0xffff0000, v9
    v_lshlrev_b32 v132, 16, v10
    v_and_b32 v133, 0xffff0000, v10
    v_lshlrev_b32 v134, 16, v11
    v_and_b32 v135, 0xffff0000, v11
    s_waitcnt lgkmcnt(4)
    v_add_f32 v128, v128, v52
    v_add_f32 v129, v129, v53
    v_add_f32 v130, v130, v54
    v_add_f32 v131, v131, v55
    v_add_f32 v132, v132, v56
    v_add_f32 v133, v133, v57
    v_add_f32 v134, v134, v58
    v_add_f32 v135, v135, v59
    s_waitcnt lgkmcnt(2)
    v_add_f32 v60, v60, v68
    v_add_f32 v61, v61, v69
    v_add_f32 v62, v62, v70
    v_add_f32 v63, v63, v71
    v_add_f32 v64, v64, v72
    v_add_f32 v65, v65, v73
    v_add_f32 v66, v66, v74
    v_add_f32 v67, v67, v75
    s_waitcnt lgkmcnt(0)
    v_add_f32 v128, v128, v76
    v_add_f32 v129, v129, v77
    v_add_f32 v130, v130, v78
    v_add_f32 v131, v131, v79
    v_add_f32 v132, v132, v80
    v_add_f32 v133, v133, v81
    v_add_f32 v134, v134, v82
    v_add_f32 v135, v135, v83
    v_add_f32 v128, v128, v60
    v_add_f32 v129, v129, v61
    v_add_f32 v130, v130, v62
    v_add_f32 v131, v131, v63
    v_add_f32 v132, v132, v64
    v_add_f32 v133, v133, v65
    v_add_f32 v134, v134, v66
    v_add_f32 v135, v135, v67
    v_lshlrev_b32 v136, 16, v12
    v_and_b32 v137, 0xffff0000, v12
    v_lshlrev_b32 v138, 16, v13
    v_and_b32 v139, 0xffff0000, v13
    v_lshlrev_b32 v140, 16, v14
    v_and_b32 v141, 0xffff0000, v14
    v_lshlrev_b32 v142, 16, v15
    v_and_b32 v143, 0xffff0000, v15
    v_lshlrev_b32 v144, 16, v16
    v_and_b32 v145, 0xffff0000, v16
    v_lshlrev_b32 v146, 16, v17
    v_and_b32 v147, 0xffff0000, v17
    v_lshlrev_b32 v148, 16, v18
    v_and_b32 v149, 0xffff0000, v18
    v_lshlrev_b32 v150, 16, v19
    v_and_b32 v151, 0xffff0000, v19
    s_mov_b32 s59, 0
.L47_para:
    ds_read_b32 v255, v251 offset:48
    s_add_u32 s59, s59, 1
    s_cmp_lt_u32 s59, 0x100000
    s_cselect_b64 s[62:63], -1, 0
    s_waitcnt lgkmcnt(0)
    v_cmp_ne_u32 vcc, 4, v255
    s_nop 0
    s_and_b64 vcc, vcc, s[62:63]
    s_cbranch_scc1 .L47_para
    ds_read_b128 v[20:23], v3 offset:0
    ds_read_b128 v[24:27], v3 offset:16
    ds_read_b128 v[28:31], v3 offset:16128
    ds_read_b128 v[32:35], v3 offset:16144
    ds_read_b128 v[36:39], v3 offset:32256
    ds_read_b128 v[40:43], v3 offset:32272
    ds_read_b128 v[44:47], v3 offset:48384
    ds_read_b128 v[48:51], v3 offset:48400
    s_waitcnt lgkmcnt(4)
    v_add_f32 v120, v120, v20
    v_add_f32 v121, v121, v21
    v_add_f32 v122, v122, v22
    v_add_f32 v123, v123, v23
    v_add_f32 v124, v124, v24
    v_add_f32 v125, v125, v25
    v_add_f32 v126, v126, v26
    v_add_f32 v127, v127, v27
    s_waitcnt lgkmcnt(2)
    v_add_f32 v28, v28, v36
    v_add_f32 v29, v29, v37
    v_add_f32 v30, v30, v38
    v_add_f32 v31, v31, v39
    v_add_f32 v32, v32, v40
    v_add_f32 v33, v33, v41
    v_add_f32 v34, v34, v42
    v_add_f32 v35, v35, v43
    s_waitcnt lgkmcnt(0)
    v_add_f32 v120, v120, v44
    v_add_f32 v121, v121, v45
    v_add_f32 v122, v122, v46
    v_add_f32 v123, v123, v47
    v_add_f32 v124, v124, v48
    v_add_f32 v125, v125, v49
    v_add_f32 v126, v126, v50
    v_add_f32 v127, v127, v51
    v_add_f32 v120, v120, v28
    v_add_f32 v121, v121, v29
    v_add_f32 v122, v122, v30
    v_add_f32 v123, v123, v31
    v_add_f32 v124, v124, v32
    v_add_f32 v125, v125, v33
    v_add_f32 v126, v126, v34
    v_add_f32 v127, v127, v35
    v_cvt_pk_bf16_f32 v120, v120, v121
    v_cvt_pk_bf16_f32 v121, v122, v123
    v_cvt_pk_bf16_f32 v122, v124, v125
    v_cvt_pk_bf16_f32 v123, v126, v127
    buffer_store_dwordx4 v[120:123], v248, s[28:31], s8 offen sc1
    s_mov_b32 s59, 0
.L48_para:
    ds_read_b32 v255, v251 offset:52
    s_add_u32 s59, s59, 1
    s_cmp_lt_u32 s59, 0x100000
    s_cselect_b64 s[62:63], -1, 0
    s_waitcnt lgkmcnt(0)
    v_cmp_ne_u32 vcc, 4, v255
    s_nop 0
    s_and_b64 vcc, vcc, s[62:63]
    s_cbranch_scc1 .L48_para
    ds_read_b128 v[20:23], v3 offset:5376
    ds_read_b128 v[24:27], v3 offset:5392
    ds_read_b128 v[28:31], v3 offset:21504
    ds_read_b128 v[32:35], v3 offset:21520
    ds_read_b128 v[36:39], v3 offset:37632
    ds_read_b128 v[40:43], v3 offset:37648
    ds_read_b128 v[44:47], v3 offset:53760
    ds_read_b128 v[48:51], v3 offset:53776
    s_waitcnt lgkmcnt(4)
    v_add_f32 v128, v128, v20
    v_add_f32 v129, v129, v21
    v_add_f32 v130, v130, v22
    v_add_f32 v131, v131, v23
    v_add_f32 v132, v132, v24
    v_add_f32 v133, v133, v25
    v_add_f32 v134, v134, v26
    v_add_f32 v135, v135, v27
    s_waitcnt lgkmcnt(2)
    v_add_f32 v28, v28, v36
    v_add_f32 v29, v29, v37
    v_add_f32 v30, v30, v38
    v_add_f32 v31, v31, v39
    v_add_f32 v32, v32, v40
    v_add_f32 v33, v33, v41
    v_add_f32 v34, v34, v42
    v_add_f32 v35, v35, v43
    s_waitcnt lgkmcnt(0)
    v_add_f32 v128, v128, v44
    v_add_f32 v129, v129, v45
    v_add_f32 v130, v130, v46
    v_add_f32 v131, v131, v47
    v_add_f32 v132, v132, v48
    v_add_f32 v133, v133, v49
    v_add_f32 v134, v134, v50
    v_add_f32 v135, v135, v51
    v_add_f32 v128, v128, v28
    v_add_f32 v129, v129, v29
    v_add_f32 v130, v130, v30
    v_add_f32 v131, v131, v31
    v_add_f32 v132, v132, v32
    v_add_f32 v133, v133, v33
    v_add_f32 v134, v134, v34
    v_add_f32 v135, v135, v35
    v_cvt_pk_bf16_f32 v128, v128, v129
    v_cvt_pk_bf16_f32 v129, v130, v131
    v_cvt_pk_bf16_f32 v130, v132, v133
    v_cvt_pk_bf16_f32 v131, v134, v135
    buffer_store_dwordx4 v[128:131], v248, s[28:31], s9 offen sc1
    s_mov_b32 s59, 0
.L49_para:
    ds_read_b32 v255, v251 offset:56
    s_add_u32 s59, s59, 1
    s_cmp_lt_u32 s59, 0x100000
    s_cselect_b64 s[62:63], -1, 0
    s_waitcnt lgkmcnt(0)
    v_cmp_ne_u32 vcc, 4, v255
    s_nop 0
    s_and_b64 vcc, vcc, s[62:63]
    s_cbranch_scc1 .L49_para
    ds_read_b128 v[20:23], v1 offset:10752
    ds_read_b128 v[24:27], v1 offset:10768
    ds_read_b128 v[28:31], v1 offset:32256
    ds_read_b128 v[32:35], v1 offset:32272
    ds_read_b128 v[36:39], v2 offset:10752
    ds_read_b128 v[40:43], v2 offset:10768
    ds_read_b128 v[44:47], v2 offset:32256
    ds_read_b128 v[48:51], v2 offset:32272
    s_waitcnt lgkmcnt(4)
    v_add_f32 v136, v136, v20
    v_add_f32 v137, v137, v21
    v_add_f32 v138, v138, v22
    v_add_f32 v139, v139, v23
    v_add_f32 v140, v140, v24
    v_add_f32 v141, v141, v25
    v_add_f32 v142, v142, v26
    v_add_f32 v143, v143, v27
    s_waitcnt lgkmcnt(2)
    v_add_f32 v28, v28, v36
    v_add_f32 v29, v29, v37
    v_add_f32 v30, v30, v38
    v_add_f32 v31, v31, v39
    v_add_f32 v32, v32, v40
    v_add_f32 v33, v33, v41
    v_add_f32 v34, v34, v42
    v_add_f32 v35, v35, v43
    s_waitcnt lgkmcnt(0)
    v_add_f32 v136, v136, v44
    v_add_f32 v137, v137, v45
    v_add_f32 v138, v138, v46
    v_add_f32 v139, v139, v47
    v_add_f32 v140, v140, v48
    v_add_f32 v141, v141, v49
    v_add_f32 v142, v142, v50
    v_add_f32 v143, v143, v51
    v_add_f32 v136, v136, v28
    v_add_f32 v137, v137, v29
    v_add_f32 v138, v138, v30
    v_add_f32 v139, v139, v31
    v_add_f32 v140, v140, v32
    v_add_f32 v141, v141, v33
    v_add_f32 v142, v142, v34
    v_add_f32 v143, v143, v35
    v_cvt_pk_bf16_f32 v136, v136, v137
    v_cvt_pk_bf16_f32 v137, v138, v139
    v_cvt_pk_bf16_f32 v138, v140, v141
    v_cvt_pk_bf16_f32 v139, v142, v143
    buffer_store_dwordx4 v[136:139], v248, s[28:31], s10 offen sc1
    s_mov_b32 s59, 0
.L50_para:
    ds_read_b32 v255, v251 offset:60
    s_add_u32 s59, s59, 1
    s_cmp_lt_u32 s59, 0x100000
    s_cselect_b64 s[62:63], -1, 0
    s_waitcnt lgkmcnt(0)
    v_cmp_ne_u32 vcc, 4, v255
    s_nop 0
    s_and_b64 vcc, vcc, s[62:63]
    s_cbranch_scc1 .L50_para
    ds_read_b128 v[20:23], v1 offset:16128
    ds_read_b128 v[24:27], v1 offset:16144
    ds_read_b128 v[28:31], v1 offset:37632
    ds_read_b128 v[32:35], v1 offset:37648
    ds_read_b128 v[36:39], v2 offset:16128
    ds_read_b128 v[40:43], v2 offset:16144
    ds_read_b128 v[44:47], v2 offset:37632
    ds_read_b128 v[48:51], v2 offset:37648
    s_waitcnt lgkmcnt(4)
    v_add_f32 v144, v144, v20
    v_add_f32 v145, v145, v21
    v_add_f32 v146, v146, v22
    v_add_f32 v147, v147, v23
    v_add_f32 v148, v148, v24
    v_add_f32 v149, v149, v25
    v_add_f32 v150, v150, v26
    v_add_f32 v151, v151, v27
    s_waitcnt lgkmcnt(2)
    v_add_f32 v28, v28, v36
    v_add_f32 v29, v29, v37
    v_add_f32 v30, v30, v38
    v_add_f32 v31, v31, v39
    v_add_f32 v32, v32, v40
    v_add_f32 v33, v33, v41
    v_add_f32 v34, v34, v42
    v_add_f32 v35, v35, v43
    s_waitcnt lgkmcnt(0)
    v_add_f32 v144, v144, v44
    v_add_f32 v145, v145, v45
    v_add_f32 v146, v146, v46
    v_add_f32 v147, v147, v47
    v_add_f32 v148, v148, v48
    v_add_f32 v149, v149, v49
    v_add_f32 v150, v150, v50
    v_add_f32 v151, v151, v51
    v_add_f32 v144, v144, v28
    v_add_f32 v145, v145, v29
    v_add_f32 v146, v146, v30
    v_add_f32 v147, v147, v31
    v_add_f32 v148, v148, v32
    v_add_f32 v149, v149, v33
    v_add_f32 v150, v150, v34
    v_add_f32 v151, v151, v35
    v_cvt_pk_bf16_f32 v144, v144, v145
    v_cvt_pk_bf16_f32 v145, v146, v147
    v_cvt_pk_bf16_f32 v146, v148, v149
    v_cvt_pk_bf16_f32 v147, v150, v151
    buffer_store_dwordx4 v[144:147], v248, s[28:31], s11 offen sc1
    s_mov_b32 exec_hi, -1
    s_endpgm
    .p2align 6
.Lp2y:
    s_setprio 1
    s_mul_i32 s56, s68, 1344
    s_sub_u32 s56, 86016, s56
    v_add_u32 v248, s56, v250
    s_cmp_lg_u32 s48, 6
    s_cbranch_scc1 .L52_para
    s_cmp_lg_u32 s65, 0
    s_cbranch_scc1 .L52_para
    s_mov_b32 s59, 0
.L51_para:
    s_buffer_load_dwordx8 s[40:47], s[36:39], s52 offset:3584 glc
    s_buffer_load_dwordx4 s[32:35], s[36:39], s52 offset:3616 glc
    s_waitcnt lgkmcnt(0)
    s_xor_b64 s[40:41], s[40:41], s[22:23]
    s_xor_b64 s[42:43], s[42:43], s[22:23]
    s_xor_b64 s[44:45], s[44:45], s[22:23]
    s_xor_b64 s[46:47], s[46:47], s[22:23]
    s_xor_b64 s[32:33], s[32:33], s[22:23]
    s_xor_b64 s[34:35], s[34:35], s[22:23]
    s_or_b64 s[40:41], s[40:41], s[42:43]
    s_or_b64 s[40:41], s[40:41], s[44:45]
    s_or_b64 s[40:41], s[40:41], s[46:47]
    s_or_b64 s[40:41], s[40:41], s[32:33]
    s_or_b64 s[40:41], s[40:41], s[34:35]
    s_cbranch_scc0 .L53_para
    s_add_u32 s59, s59, 1
    s_sleep 2
    s_cmp_lt_u32 s59, 0x40000
    s_cbranch_scc1 .L51_para
.L53_para:
    s_mov_b64 exec, 1
    ds_write_b32 v251, v253 offset:8
    s_mov_b64 exec, -1
.L52_para:
    s_waitcnt vmcnt(5)
    v_mfma_f32_16x16x32_bf16 v[180:183], v[0:3], v[220:223], 0
    v_mfma_f32_16x16x32_bf16 v[184:187], v[4:7], v[220:223], 0
    v_mfma_f32_16x16x32_bf16 v[188:191], v[8:11], v[220:223], 0
    v_mfma_f32_16x16x32_bf16 v[192:195], v[12:15], v[220:223], 0
    v_mfma_f32_16x16x32_bf16 v[196:199], v[16:19], v[220:223], 0
    s_waitcnt vmcnt(4)
    v_mfma_f32_16x16x32_bf16 v[180:183], v[20:23], v[224:227], v[180:183]
    v_mfma_f32_16x16x32_bf16 v[184:187], v[24:27], v[224:227], v[184:187]
    v_mfma_f32_16x16x32_bf16 v[188:191], v[28:31], v[224:227], v[188:191]
    v_mfma_f32_16x16x32_bf16 v[192:195], v[32:35], v[224:227], v[192:195]
    v_mfma_f32_16x16x32_bf16 v[196:199], v[36:39], v[224:227], v[196:199]
    s_waitcnt vmcnt(3)
    v_mfma_f32_16x16x32_bf16 v[180:183], v[40:43], v[228:231], v[180:183]
    v_mfma_f32_16x16x32_bf16 v[184:187], v[44:47], v[228:231], v[184:187]
    v_mfma_f32_16x16x32_bf16 v[188:191], v[48:51], v[228:231], v[188:191]
    v_mfma_f32_16x16x32_bf16 v[192:195], v[52:55], v[228:231], v[192:195]
    v_mfma_f32_16x16x32_bf16 v[196:199], v[56:59], v[228:231], v[196:199]
    s_waitcnt vmcnt(2)
    v_mfma_f32_16x16x32_bf16 v[200:203], v[0:3], v[232:235], 0
    v_mfma_f32_16x16x32_bf16 v[204:207], v[4:7], v[232:235], 0
    v_mfma_f32_16x16x32_bf16 v[208:211], v[8:11], v[232:235], 0
    v_mfma_f32_16x16x32_bf16 v[212:215], v[12:15], v[232:235], 0
    v_mfma_f32_16x16x32_bf16 v[216:219], v[16:19], v[232:235], 0
    s_waitcnt vmcnt(1)
    v_mfma_f32_16x16x32_bf16 v[200:203], v[20:23], v[236:239], v[200:203]
    v_mfma_f32_16x16x32_bf16 v[204:207], v[24:27], v[236:239], v[204:207]
    v_mfma_f32_16x16x32_bf16 v[208:211], v[28:31], v[236:239], v[208:211]
    v_mfma_f32_16x16x32_bf16 v[212:215], v[32:35], v[236:239], v[212:215]
    v_mfma_f32_16x16x32_bf16 v[216:219], v[36:39], v[236:239], v[216:219]
    s_waitcnt vmcnt(0)
    v_mfma_f32_16x16x32_bf16 v[200:203], v[40:43], v[240:243], v[200:203]
    v_mfma_f32_16x16x32_bf16 v[204:207], v[44:47], v[240:243], v[204:207]
    v_mfma_f32_16x16x32_bf16 v[208:211], v[48:51], v[240:243], v[208:211]
    v_mfma_f32_16x16x32_bf16 v[212:215], v[52:55], v[240:243], v[212:215]
    v_mfma_f32_16x16x32_bf16 v[216:219], v[56:59], v[240:243], v[216:219]
    s_cmp_ge_u32 s51, 14
    s_cbranch_scc1 .L54_para
    s_add_u32 s64, s0, 163840
    buffer_load_dwordx4 v[140:143], v249, s[36:39], s64 offen offset:0 sc1
    s_add_u32 s64, s0, 163840
    buffer_load_dwordx4 v[144:147], v249, s[36:39], s64 offen offset:1024 sc1
    s_add_u32 s64, s0, 163840
    buffer_load_dwordx4 v[148:151], v249, s[36:39], s64 offen offset:2048 sc1
    s_add_u32 s64, s0, 163840
    buffer_load_dwordx4 v[152:155], v249, s[36:39], s64 offen offset:3072 sc1
    s_add_u32 s64, s0, 167936
    buffer_load_dwordx4 v[156:159], v249, s[36:39], s64 offen offset:0 sc1
.L54_para:
    s_mov_b32 s59, 0
.L55_para:
    ds_read_b32 v255, v251 offset:28
    s_add_u32 s59, s59, 1
    s_cmp_lt_u32 s59, 0x100000
    s_cselect_b64 s[62:63], -1, 0
    s_waitcnt lgkmcnt(0)
    v_cmp_ne_u32 vcc, 8, v255
    s_nop 0
    s_and_b64 vcc, vcc, s[62:63]
    s_cbranch_scc1 .L55_para
    s_cmp_lg_u32 s48, 7
    s_cbranch_scc1 .L57_para
    s_mov_b32 s59, 0
.L56_para:
    s_buffer_load_dwordx8 s[40:47], s[36:39], s14 glc
    s_buffer_load_dwordx8 s[72:79], s[36:39], s21 glc
    s_waitcnt lgkmcnt(0)
    s_xor_b64 s[40:41], s[40:41], s[22:23]
    s_xor_b64 s[42:43], s[42:43], s[22:23]
    s_xor_b64 s[44:45], s[44:45], s[22:23]
    s_xor_b64 s[46:47], s[46:47], s[22:23]
    s_xor_b64 s[72:73], s[72:73], s[22:23]
    s_xor_b64 s[74:75], s[74:75], s[22:23]
    s_xor_b64 s[76:77], s[76:77], s[22:23]
    s_xor_b64 s[78:79], s[78:79], s[22:23]
    s_or_b64 s[40:41], s[40:41], s[42:43]
    s_or_b64 s[40:41], s[40:41], s[44:45]
    s_or_b64 s[40:41], s[40:41], s[46:47]
    s_or_b64 s[40:41], s[40:41], s[72:73]
    s_or_b64 s[40:41], s[40:41], s[74:75]
    s_or_b64 s[40:41], s[40:41], s[76:77]
    s_or_b64 s[40:41], s[40:41], s[78:79]
    s_cbranch_scc0 .L58_para
    s_add_u32 s59, s59, 1
    s_sleep 2
    s_cmp_lt_u32 s59, 0x40000
    s_cbranch_scc1 .L56_para
.L58_para:
    s_mov_b64 exec, 1
    ds_write_b32 v251, v253 offset:12
    s_mov_b64 exec, -1
.L57_para:
    s_mov_b32 s59, 0
.L59_para:
    ds_read_b64 v[246:247], v251 offset:8
    s_add_u32 s59, s59, 1
    s_cmp_lt_u32 s59, 0x100000
    s_cselect_b64 s[62:63], -1, 0
    s_waitcnt lgkmcnt(0)
    v_or_b32 v246, s65, v246
    v_and_b32 v246, v246, v247
    v_cmp_ne_u32 vcc, 1, v246
    s_nop 0
    s_and_b64 vcc, vcc, s[62:63]
    s_cbranch_scc1 .L59_para
    s_add_u32 s12, s4, s58
    buffer_load_dwordx4 v[220:223], v249, s[36:39], s12 offen offset:0 sc1
    buffer_load_dwordx4 v[224:227], v249, s[36:39], s12 offen offset:1024 sc1
    buffer_load_dwordx4 v[228:231], v249, s[36:39], s12 offen offset:2048 sc1
    buffer_load_dwordx4 v[232:235], v249, s[36:39], s12 offen offset:3072 sc1
    s_add_u32 s12, s12, 4096
    buffer_load_dwordx4 v[236:239], v249, s[36:39], s12 offen offset:0 sc1
    s_add_u32 s12, s5, s58
    buffer_load_dwordx4 v[240:243], v249, s[36:39], s12 offen offset:0 sc1
    buffer_load_dwordx4 v[244:247], v249, s[36:39], s12 offen offset:1024 sc1
    s_setprio 1
    s_waitcnt vmcnt(6)
    v_mfma_f32_16x16x32_bf16 v[180:183], v[60:63], v[220:223], v[180:183]
    v_mfma_f32_16x16x32_bf16 v[184:187], v[64:67], v[220:223], v[184:187]
    v_mfma_f32_16x16x32_bf16 v[188:191], v[68:71], v[220:223], v[188:191]
    v_mfma_f32_16x16x32_bf16 v[192:195], v[72:75], v[220:223], v[192:195]
    v_mfma_f32_16x16x32_bf16 v[196:199], v[76:79], v[220:223], v[196:199]
    buffer_load_dwordx4 v[160:163], v249, s[36:39], s12 offen offset:2048 sc1
    buffer_load_dwordx4 v[164:167], v249, s[36:39], s12 offen offset:3072 sc1
    s_waitcnt vmcnt(7)
    v_mfma_f32_16x16x32_bf16 v[180:183], v[80:83], v[224:227], v[180:183]
    v_mfma_f32_16x16x32_bf16 v[184:187], v[84:87], v[224:227], v[184:187]
    v_mfma_f32_16x16x32_bf16 v[188:191], v[88:91], v[224:227], v[188:191]
    v_mfma_f32_16x16x32_bf16 v[192:195], v[92:95], v[224:227], v[192:195]
    v_mfma_f32_16x16x32_bf16 v[196:199], v[96:99], v[224:227], v[196:199]
    s_add_u32 s12, s12, 4096
    buffer_load_dwordx4 v[168:171], v249, s[36:39], s12 offen offset:0 sc1
    buffer_load_dwordx4 v[172:175], v249, s[36:39], s6 offen offset:0 sc1
    s_waitcnt vmcnt(8)
    v_mfma_f32_16x16x32_bf16 v[180:183], v[100:103], v[228:231], v[180:183]
    s_waitcnt vmcnt(7)
    v_mfma_f32_16x16x32_bf16 v[180:183], v[120:123], v[232:235], v[180:183]
    s_waitcnt vmcnt(6)
    v_mfma_f32_16x16x32_bf16 v[180:183], v[140:143], v[236:239], v[180:183]
    buffer_load_dwordx4 v[176:179], v249, s[36:39], s6 offen offset:1024 sc1
    v_mfma_f32_16x16x32_bf16 v[184:187], v[104:107], v[228:231], v[184:187]
    v_mfma_f32_16x16x32_bf16 v[184:187], v[124:127], v[232:235], v[184:187]
    v_mfma_f32_16x16x32_bf16 v[184:187], v[144:147], v[236:239], v[184:187]
    buffer_load_dwordx4 v[220:223], v249, s[36:39], s6 offen offset:2048 sc1
    v_mfma_f32_16x16x32_bf16 v[188:191], v[108:111], v[228:231], v[188:191]
    v_mfma_f32_16x16x32_bf16 v[188:191], v[128:131], v[232:235], v[188:191]
    v_mfma_f32_16x16x32_bf16 v[188:191], v[148:151], v[236:239], v[188:191]
    ds_write_b128 v248, v[180:183] offset:0
    s_add_u32 s12, s6, s58
    buffer_load_dwordx4 v[224:227], v249, s[36:39], s12 offen offset:0 sc1
    v_mfma_f32_16x16x32_bf16 v[192:195], v[112:115], v[228:231], v[192:195]
    v_mfma_f32_16x16x32_bf16 v[192:195], v[132:135], v[232:235], v[192:195]
    v_mfma_f32_16x16x32_bf16 v[192:195], v[152:155], v[236:239], v[192:195]
    ds_write_b128 v248, v[184:187] offset:64
    v_mfma_f32_16x16x32_bf16 v[196:199], v[116:119], v[228:231], v[196:199]
    v_mfma_f32_16x16x32_bf16 v[196:199], v[136:139], v[232:235], v[196:199]
    v_mfma_f32_16x16x32_bf16 v[196:199], v[156:159], v[236:239], v[196:199]
    ds_write_b128 v248, v[188:191] offset:128
    buffer_load_dwordx4 v[228:231], v249, s[36:39], s12 offen offset:1024 sc1
    buffer_load_dwordx4 v[232:235], v249, s[36:39], s12 offen offset:2048 sc1
    s_waitcnt vmcnt(10)
    v_mfma_f32_16x16x32_bf16 v[200:203], v[60:63], v[240:243], v[200:203]
    v_mfma_f32_16x16x32_bf16 v[204:207], v[64:67], v[240:243], v[204:207]
    v_mfma_f32_16x16x32_bf16 v[208:211], v[68:71], v[240:243], v[208:211]
    ds_write_b128 v248, v[192:195] offset:192
    v_mfma_f32_16x16x32_bf16 v[212:215], v[72:75], v[240:243], v[212:215]
    v_mfma_f32_16x16x32_bf16 v[216:219], v[76:79], v[240:243], v[216:219]
    buffer_load_dwordx4 v[236:239], v249, s[36:39], s12 offen offset:3072 sc1
    s_add_u32 s12, s12, 4096
    buffer_load_dwordx4 v[240:243], v249, s[36:39], s12 offen offset:0 sc1
    s_waitcnt vmcnt(11)
    v_mfma_f32_16x16x32_bf16 v[200:203], v[80:83], v[244:247], v[200:203]
    v_mfma_f32_16x16x32_bf16 v[204:207], v[84:87], v[244:247], v[204:207]
    ds_write_b128 v248, v[196:199] offset:256
    v_mfma_f32_16x16x32_bf16 v[208:211], v[88:91], v[244:247], v[208:211]
    s_mov_b64 exec, 1
    ds_add_u32 v251, v253 offset:48
    s_mov_b64 exec, -1
    v_mfma_f32_16x16x32_bf16 v[212:215], v[92:95], v[244:247], v[212:215]
    ds_read_b32 v255, v252 offset:32
    v_mfma_f32_16x16x32_bf16 v[216:219], v[96:99], v[244:247], v[216:219]
    buffer_load_dwordx4 v[244:247], v249, s[36:39], s7 offen offset:0 sc1
    s_waitcnt vmcnt(11)
    v_mfma_f32_16x16x32_bf16 v[200:203], v[100:103], v[160:163], v[200:203]
    v_mfma_f32_16x16x32_bf16 v[204:207], v[104:107], v[160:163], v[204:207]
    v_mfma_f32_16x16x32_bf16 v[208:211], v[108:111], v[160:163], v[208:211]
    s_waitcnt lgkmcnt(0)
    v_cmp_gt_u32 vcc, 2, v255
    s_mov_b32 s59, 0
    s_cbranch_vccnz .L60_para
.L61_para:
    v_mfma_f32_16x16x32_bf16 v[212:215], v[112:115], v[160:163], v[212:215]
    ds_read_b128 v[180:183], v250 offset:10752
    v_mfma_f32_16x16x32_bf16 v[216:219], v[116:119], v[160:163], v[216:219]
    ds_read_b128 v[184:187], v250 offset:10816
    buffer_load_dwordx4 v[160:163], v249, s[36:39], s7 offen offset:1024 sc1
    s_waitcnt vmcnt(11)
    v_mfma_f32_16x16x32_bf16 v[200:203], v[120:123], v[164:167], v[200:203]
    ds_read_b128 v[188:191], v250 offset:10880
    v_mfma_f32_16x16x32_bf16 v[204:207], v[124:127], v[164:167], v[204:207]
    ds_read_b128 v[192:195], v250 offset:10944
    v_mfma_f32_16x16x32_bf16 v[208:211], v[128:131], v[164:167], v[208:211]
    ds_read_b128 v[196:199], v250 offset:11008
    v_mfma_f32_16x16x32_bf16 v[212:215], v[132:135], v[164:167], v[212:215]
    v_mfma_f32_16x16x32_bf16 v[216:219], v[136:139], v[164:167], v[216:219]
    buffer_load_dwordx4 v[164:167], v249, s[36:39], s7 offen offset:2048 sc1
    s_waitcnt vmcnt(11)
    v_mfma_f32_16x16x32_bf16 v[200:203], v[140:143], v[168:171], v[200:203]
    v_mfma_f32_16x16x32_bf16 v[204:207], v[144:147], v[168:171], v[204:207]
    v_mfma_f32_16x16x32_bf16 v[208:211], v[148:151], v[168:171], v[208:211]
    v_mfma_f32_16x16x32_bf16 v[212:215], v[152:155], v[168:171], v[212:215]
    v_mfma_f32_16x16x32_bf16 v[216:219], v[156:159], v[168:171], v[216:219]
    s_add_u32 s12, s7, s58
    buffer_load_dwordx4 v[168:171], v249, s[36:39], s12 offen offset:0 sc1
    s_waitcnt vmcnt(11) lgkmcnt(4)
    v_mfma_f32_16x16x32_bf16 v[180:183], v[0:3], v[172:175], v[180:183]
    s_waitcnt lgkmcnt(3)
    v_mfma_f32_16x16x32_bf16 v[184:187], v[4:7], v[172:175], v[184:187]
    s_waitcnt lgkmcnt(2)
    v_mfma_f32_16x16x32_bf16 v[188:191], v[8:11], v[172:175], v[188:191]
    ds_write_b128 v248, v[200:203] offset:5376
    s_waitcnt lgkmcnt(2)
    v_mfma_f32_16x16x32_bf16 v[192:195], v[12:15], v[172:175], v[192:195]
    s_waitcnt lgkmcnt(1)
    v_mfma_f32_16x16x32_bf16 v[196:199], v[16:19], v[172:175], v[196:199]
    buffer_load_dwordx4 v[172:175], v249, s[36:39], s12 offen offset:1024 sc1
    s_waitcnt vmcnt(11)
    v_mfma_f32_16x16x32_bf16 v[180:183], v[20:23], v[176:179], v[180:183]
    v_mfma_f32_16x16x32_bf16 v[184:187], v[24:27], v[176:179], v[184:187]
    v_mfma_f32_16x16x32_bf16 v[188:191], v[28:31], v[176:179], v[188:191]
    ds_write_b128 v248, v[204:207] offset:5440
    v_mfma_f32_16x16x32_bf16 v[192:195], v[32:35], v[176:179], v[192:195]
    v_mfma_f32_16x16x32_bf16 v[196:199], v[36:39], v[176:179], v[196:199]
    buffer_load_dwordx4 v[176:179], v249, s[36:39], s12 offen offset:2048 sc1
    s_waitcnt vmcnt(11)
    v_mfma_f32_16x16x32_bf16 v[180:183], v[40:43], v[220:223], v[180:183]
    v_mfma_f32_16x16x32_bf16 v[184:187], v[44:47], v[220:223], v[184:187]
    v_mfma_f32_16x16x32_bf16 v[188:191], v[48:51], v[220:223], v[188:191]
    ds_write_b128 v248, v[208:211] offset:5504
    v_mfma_f32_16x16x32_bf16 v[192:195], v[52:55], v[220:223], v[192:195]
    v_mfma_f32_16x16x32_bf16 v[196:199], v[56:59], v[220:223], v[196:199]
    buffer_load_dwordx4 v[220:223], v249, s[36:39], s12 offen offset:3072 sc1
    s_waitcnt vmcnt(11)
    v_mfma_f32_16x16x32_bf16 v[180:183], v[60:63], v[224:227], v[180:183]
    v_mfma_f32_16x16x32_bf16 v[184:187], v[64:67], v[224:227], v[184:187]
    v_mfma_f32_16x16x32_bf16 v[188:191], v[68:71], v[224:227], v[188:191]
    ds_write_b128 v248, v[212:215] offset:5568
    v_mfma_f32_16x16x32_bf16 v[192:195], v[72:75], v[224:227], v[192:195]
    v_mfma_f32_16x16x32_bf16 v[196:199], v[76:79], v[224:227], v[196:199]
    s_add_u32 s12, s12, 4096
    buffer_load_dwordx4 v[224:227], v249, s[36:39], s12 offen offset:0 sc1
    s_waitcnt vmcnt(11)
    v_mfma_f32_16x16x32_bf16 v[180:183], v[80:83], v[228:231], v[180:183]
    v_mfma_f32_16x16x32_bf16 v[184:187], v[84:87], v[228:231], v[184:187]
    v_mfma_f32_16x16x32_bf16 v[188:191], v[88:91], v[228:231], v[188:191]
    ds_write_b128 v248, v[216:219] offset:5632
    v_mfma_f32_16x16x32_bf16 v[192:195], v[92:95], v[228:231], v[192:195]
    s_mov_b64 exec, 1
    ds_add_u32 v251, v253 offset:52
    s_mov_b64 exec, -1
    v_mfma_f32_16x16x32_bf16 v[196:199], v[96:99], v[228:231], v[196:199]
    ds_read_b32 v255, v252 offset:32
    s_waitcnt vmcnt(10)
    v_mfma_f32_16x16x32_bf16 v[180:183], v[100:103], v[232:235], v[180:183]
    v_mfma_f32_16x16x32_bf16 v[184:187], v[104:107], v[232:235], v[184:187]
    v_mfma_f32_16x16x32_bf16 v[188:191], v[108:111], v[232:235], v[188:191]
    v_mfma_f32_16x16x32_bf16 v[192:195], v[112:115], v[232:235], v[192:195]
    s_waitcnt lgkmcnt(0)
    v_cmp_gt_u32 vcc, 3, v255
    s_mov_b32 s59, 0
    s_cbranch_vccnz .L63_para
.L64_para:
    v_mfma_f32_16x16x32_bf16 v[196:199], v[116:119], v[232:235], v[196:199]
    ds_read_b128 v[200:203], v250 offset:16128
    s_waitcnt vmcnt(9)
    v_mfma_f32_16x16x32_bf16 v[180:183], v[120:123], v[236:239], v[180:183]
    ds_read_b128 v[204:207], v250 offset:16192
    v_mfma_f32_16x16x32_bf16 v[184:187], v[124:127], v[236:239], v[184:187]
    ds_read_b128 v[208:211], v250 offset:16256
    v_mfma_f32_16x16x32_bf16 v[188:191], v[128:131], v[236:239], v[188:191]
    ds_read_b128 v[212:215], v250 offset:16320
    v_mfma_f32_16x16x32_bf16 v[192:195], v[132:135], v[236:239], v[192:195]
    ds_read_b128 v[216:219], v250 offset:16384
    v_mfma_f32_16x16x32_bf16 v[196:199], v[136:139], v[236:239], v[196:199]
    s_waitcnt vmcnt(8)
    v_mfma_f32_16x16x32_bf16 v[180:183], v[140:143], v[240:243], v[180:183]
    v_mfma_f32_16x16x32_bf16 v[184:187], v[144:147], v[240:243], v[184:187]
    v_mfma_f32_16x16x32_bf16 v[188:191], v[148:151], v[240:243], v[188:191]
    v_mfma_f32_16x16x32_bf16 v[192:195], v[152:155], v[240:243], v[192:195]
    v_mfma_f32_16x16x32_bf16 v[196:199], v[156:159], v[240:243], v[196:199]
    s_waitcnt vmcnt(7) lgkmcnt(4)
    v_mfma_f32_16x16x32_bf16 v[200:203], v[0:3], v[244:247], v[200:203]
    s_waitcnt lgkmcnt(3)
    v_mfma_f32_16x16x32_bf16 v[204:207], v[4:7], v[244:247], v[204:207]
    s_waitcnt lgkmcnt(2)
    v_mfma_f32_16x16x32_bf16 v[208:211], v[8:11], v[244:247], v[208:211]
    ds_write_b128 v250, v[180:183] offset:10752
    s_waitcnt lgkmcnt(2)
    v_mfma_f32_16x16x32_bf16 v[212:215], v[12:15], v[244:247], v[212:215]
    s_waitcnt lgkmcnt(1)
    v_mfma_f32_16x16x32_bf16 v[216:219], v[16:19], v[244:247], v[216:219]
    s_waitcnt vmcnt(6)
    v_mfma_f32_16x16x32_bf16 v[200:203], v[20:23], v[160:163], v[200:203]
    v_mfma_f32_16x16x32_bf16 v[204:207], v[24:27], v[160:163], v[204:207]
    v_mfma_f32_16x16x32_bf16 v[208:211], v[28:31], v[160:163], v[208:211]
    v_mfma_f32_16x16x32_bf16 v[212:215], v[32:35], v[160:163], v[212:215]
    ds_write_b128 v250, v[184:187] offset:10816
    v_mfma_f32_16x16x32_bf16 v[216:219], v[36:39], v[160:163], v[216:219]
    s_waitcnt vmcnt(5)
    v_mfma_f32_16x16x32_bf16 v[200:203], v[40:43], v[164:167], v[200:203]
    v_mfma_f32_16x16x32_bf16 v[204:207], v[44:47], v[164:167], v[204:207]
    v_mfma_f32_16x16x32_bf16 v[208:211], v[48:51], v[164:167], v[208:211]
    v_mfma_f32_16x16x32_bf16 v[212:215], v[52:55], v[164:167], v[212:215]
    v_mfma_f32_16x16x32_bf16 v[216:219], v[56:59], v[164:167], v[216:219]
    ds_write_b128 v250, v[188:191] offset:10880
    s_waitcnt vmcnt(4)
    v_mfma_f32_16x16x32_bf16 v[200:203], v[60:63], v[168:171], v[200:203]
    v_mfma_f32_16x16x32_bf16 v[204:207], v[64:67], v[168:171], v[204:207]
    v_mfma_f32_16x16x32_bf16 v[208:211], v[68:71], v[168:171], v[208:211]
    v_mfma_f32_16x16x32_bf16 v[212:215], v[72:75], v[168:171], v[212:215]
    v_mfma_f32_16x16x32_bf16 v[216:219], v[76:79], v[168:171], v[216:219]
    s_waitcnt vmcnt(3)
    v_mfma_f32_16x16x32_bf16 v[200:203], v[80:83], v[172:175], v[200:203]
    ds_write_b128 v250, v[192:195] offset:10944
    v_mfma_f32_16x16x32_bf16 v[204:207], v[84:87], v[172:175], v[204:207]
    v_mfma_f32_16x16x32_bf16 v[208:211], v[88:91], v[172:175], v[208:211]
    v_mfma_f32_16x16x32_bf16 v[212:215], v[92:95], v[172:175], v[212:215]
    v_mfma_f32_16x16x32_bf16 v[216:219], v[96:99], v[172:175], v[216:219]
    s_waitcnt vmcnt(2)
    v_mfma_f32_16x16x32_bf16 v[200:203], v[100:103], v[176:179], v[200:203]
    s_waitcnt vmcnt(1)
    v_mfma_f32_16x16x32_bf16 v[200:203], v[120:123], v[220:223], v[200:203]
    ds_write_b128 v250, v[196:199] offset:11008
    s_waitcnt vmcnt(0)
    v_mfma_f32_16x16x32_bf16 v[200:203], v[140:143], v[224:227], v[200:203]
    s_mov_b64 exec, 1
    ds_add_u32 v251, v253 offset:56
    s_mov_b64 exec, -1
    v_mfma_f32_16x16x32_bf16 v[204:207], v[104:107], v[176:179], v[204:207]
    v_mfma_f32_16x16x32_bf16 v[204:207], v[124:127], v[220:223], v[204:207]
    v_mfma_f32_16x16x32_bf16 v[204:207], v[144:147], v[224:227], v[204:207]
    v_mfma_f32_16x16x32_bf16 v[208:211], v[108:111], v[176:179], v[208:211]
    v_mfma_f32_16x16x32_bf16 v[208:211], v[128:131], v[220:223], v[208:211]
    v_mfma_f32_16x16x32_bf16 v[208:211], v[148:151], v[224:227], v[208:211]
    ds_write_b128 v250, v[200:203] offset:16128
    v_mfma_f32_16x16x32_bf16 v[212:215], v[112:115], v[176:179], v[212:215]
    v_mfma_f32_16x16x32_bf16 v[212:215], v[132:135], v[220:223], v[212:215]
    v_mfma_f32_16x16x32_bf16 v[212:215], v[152:155], v[224:227], v[212:215]
    s_nop 0
    ds_write_b128 v250, v[204:207] offset:16192
    v_mfma_f32_16x16x32_bf16 v[216:219], v[116:119], v[176:179], v[216:219]
    v_mfma_f32_16x16x32_bf16 v[216:219], v[136:139], v[220:223], v[216:219]
    v_mfma_f32_16x16x32_bf16 v[216:219], v[156:159], v[224:227], v[216:219]
    ds_write_b128 v250, v[208:211] offset:16256
    s_nop 1
    ds_write_b128 v250, v[212:215] offset:16320
    s_nop 3
    ds_write_b128 v250, v[216:219] offset:16384
    s_mov_b64 exec, 1
    ds_add_u32 v251, v253 offset:60
    s_mov_b64 exec, -1
    s_endpgm
.L2_para:
    s_add_u32 s59, s59, 1
    s_cmp_ge_u32 s59, 0x40000
    s_cbranch_scc1 .L3_para
    s_sleep 4
    buffer_load_dword v84, off, s[40:43], 0 sc1
    s_waitcnt vmcnt(0)
    v_readfirstlane_b32 s20, v84
    s_nop 0
    s_cmp_eq_u32 s20, 0
    s_cbranch_scc1 .L2_para
    s_branch .L3_para
.L4_para:
    s_add_u32 s59, s59, 1
    s_cmp_ge_u32 s59, 0x40000
    s_cbranch_scc1 .L5_para
    s_sleep 4
    buffer_load_dwordx4 v[84:87], v88, s[36:39], 0 offen sc1
    s_waitcnt vmcnt(0)
    v_xor_b32 v84, s20, v84
    v_xor_b32 v85, s20, v85
    v_xor_b32 v86, s20, v86
    v_xor_b32 v87, s20, v87
    v_or_b32 v84, v84, v85
    v_or3_b32 v84, v84, v86, v87
    v_cmp_ne_u32 vcc, 0, v84
    s_nop 0
    s_and_b64 vcc, vcc, s[76:77]
    s_nop 0
    s_cbranch_vccnz .L4_para
    s_branch .L5_para
.L21_para:
    buffer_load_dword v114, off, s[24:27], 0
    buffer_load_dword v114, off, s[24:27], 0
    buffer_load_dword v114, off, s[24:27], 0
    buffer_load_dword v114, off, s[24:27], 0
    s_branch .L22_para
.L24_para:
    buffer_load_dword v114, off, s[24:27], 0
    buffer_load_dword v114, off, s[24:27], 0
    s_branch .L25_para
.L26_para:
    buffer_load_dword v114, off, s[24:27], 0
    buffer_load_dword v114, off, s[24:27], 0
    s_branch .L27_para
.L28_para:
    s_add_u32 s59, s59, 1
    s_cmp_ge_u32 s59, 0x40000
    s_cbranch_scc1 .L29_para
    s_sleep 4
    buffer_load_dword v144, off, s[40:43], 0 sc1
    s_waitcnt vmcnt(0)
    v_readfirstlane_b32 s20, v144
    s_nop 0
    s_cmp_eq_u32 s20, 0
    s_cbranch_scc1 .L28_para
    s_branch .L29_para
.L30_para:
    s_add_u32 s59, s59, 1
    s_cmp_ge_u32 s59, 0x40000
    s_cbranch_scc1 .L31_para
    s_sleep 4
    buffer_load_dwordx4 v[144:147], v148, s[36:39], 0 offen sc1
    s_waitcnt vmcnt(0)
    v_xor_b32 v144, s20, v144
    v_xor_b32 v145, s20, v145
    v_xor_b32 v146, s20, v146
    v_xor_b32 v147, s20, v147
    v_or_b32 v144, v144, v145
    v_or3_b32 v144, v144, v146, v147
    v_cmp_ne_u32 vcc, 0, v144
    s_nop 0
    s_and_b64 vcc, vcc, s[76:77]
    s_nop 0
    s_cbranch_vccnz .L30_para
    s_branch .L31_para
.L35_para:
    s_add_u32 s59, s59, 1
    s_cmp_ge_u32 s59, 0x40000
    s_cbranch_scc1 .L36_para
    s_sleep 3
    buffer_load_dwordx4 v[244:247], v248, s[36:39], s15 offen sc1
    s_waitcnt vmcnt(0)
    s_mov_b32 exec_hi, 0
    v_xor_b32 v244, s20, v244
    v_xor_b32 v245, s20, v245
    v_xor_b32 v246, s20, v246
    v_xor_b32 v247, s20, v247
    v_or_b32 v244, v244, v245
    v_or3_b32 v244, v244, v246, v247
    v_cmp_ne_u32 vcc, 0, v244
    s_nop 0
    s_cbranch_vccnz .L35_para
    s_branch .L36_para
.L40_para:
    s_add_u32 s59, s59, 1
    s_cmp_ge_u32 s59, 0x40000
    s_cbranch_scc1 .L41_para
    s_sleep 1
    ds_read_b32 v255, v251 offset:28
    s_waitcnt lgkmcnt(0)
    v_cmp_ne_u32 vcc, 8, v255
    s_nop 0
    s_cbranch_vccnz .L40_para
    s_branch .L41_para
.L43_para:
    s_add_u32 s59, s59, 1
    s_cmp_ge_u32 s59, 0x40000
    s_cbranch_scc1 .L44_para
    s_sleep 1
    ds_read_b32 v254, v251 offset:8
    s_waitcnt lgkmcnt(0)
    v_or_b32 v254, s65, v254
    v_cmp_ne_u32 vcc, 1, v254
    s_nop 0
    s_cbranch_vccnz .L43_para
    s_branch .L44_para
.L60_para:
    s_add_u32 s59, s59, 1
    s_cmp_ge_u32 s59, 0x40000
    s_cbranch_scc1 .L61_para
    s_sleep 1
    ds_read_b32 v255, v252 offset:32
    s_waitcnt lgkmcnt(0)
    v_cmp_gt_u32 vcc, 2, v255
    s_nop 0
    s_cbranch_vccnz .L60_para
    s_branch .L61_para
.L63_para:
    s_add_u32 s59, s59, 1
    s_cmp_ge_u32 s59, 0x40000
    s_cbranch_scc1 .L64_para
    s_sleep 1
    ds_read_b32 v255, v252 offset:32
    s_waitcnt lgkmcnt(0)
    v_cmp_gt_u32 vcc, 3, v255
    s_nop 0
    s_cbranch_vccnz .L63_para
    s_branch .L64_para
.Lexit:
    s_endpgm
.section .rodata,"a"
.p2align 6
.amdhsa_kernel parallel_sum__sliding_local_dilated__glu_gated_bilinear__prompt_kernel
  .amdhsa_next_free_vgpr 256
  .amdhsa_next_free_sgpr 102
  .amdhsa_accum_offset 256
  .amdhsa_group_segment_fixed_size 0
  .amdhsa_kernarg_size 80
  .amdhsa_user_sgpr_count 2
  .amdhsa_user_sgpr_kernarg_segment_ptr 1
  .amdhsa_system_sgpr_workgroup_id_x 1
  .amdhsa_float_denorm_mode_32 3
.end_amdhsa_kernel
```
